```python
import torch

def _softmax(x, axis=-1):
    return torch.softmax(x, dim=axis)
def _gelu(x):
    return torch.nn.functional.gelu(x, approximate="tanh")
def _silu(x):
    return torch.nn.functional.silu(x)
def _sigmoid(x):
    return torch.sigmoid(x)
def _layernorm(x, axis=-1, eps=1e-5):
    m = x.mean(dim=axis, keepdim=True)
    v = x.var(dim=axis, keepdim=True, unbiased=False)
    return (x - m) / torch.sqrt(v + eps)
def _scatter_add(tgt, idx, src, axis=0):
    return tgt.clone().index_add_(axis, idx, src)
def _segment_sum(src, seg, n):
    out = torch.zeros((n,) + src.shape[1:], dtype=src.dtype)
    return out.index_add_(0, seg, src)
def _pad(x, pw):
    flat = tuple(v for pair in reversed(pw) for v in pair)
    return torch.nn.functional.pad(x, flat)

kernel_name = 'gated_mix__ssm_conv_s4d__mixer_channel_mlp__prompt'

def setup_inputs():

    _w = (lambda a: (lambda t: t.to(torch.bfloat16) if t.is_floating_point() else t)(torch.as_tensor(a)))
    def _A_setup():
        Bsz, L, D, N = 1, 2048, 512, 128
        return {
            "u": _w((lambda *s: torch.randn(*s, dtype=torch.bfloat16) * 0.05)(Bsz, L, D)),
            "log_A_real": _w((lambda *s: torch.randn(*s, dtype=torch.bfloat16) * 3.2)(D, N) * 0.5),
            "A_imag": _w((lambda *s: torch.randn(*s, dtype=torch.bfloat16) * 0.1)(D, N) * 3.14),
            "C_real": _w((lambda *s: torch.randn(*s, dtype=torch.bfloat16) * 0.8)(D, N) / N ** 0.5),
            "C_imag": _w((lambda *s: torch.randn(*s, dtype=torch.bfloat16) * 0.8)(D, N) / N ** 0.5),
            "log_dt": _w((lambda *s: torch.randn(*s, dtype=torch.bfloat16) * 0.1)(D) * 0.5 - 4.0),
            "D_skip": _w((lambda *s: torch.randn(*s, dtype=torch.bfloat16) * 0.1)(D)),
        }
    _A_in = _A_setup()

    def _B_setup():
        B, S, D, F = 1, 2048, 512, 1792
        return {
            "x": _w((lambda *s: torch.randn(*s, dtype=torch.bfloat16) * 0.05)(B, S, D)),
            "w1": _w((lambda *s: torch.randn(*s, dtype=torch.bfloat16) * 0.8)(D, F) * (D ** -0.5)),
            "b1": _w((lambda *s: torch.randn(*s, dtype=torch.bfloat16) * 0.4)(F)),
            "w2": _w((lambda *s: torch.randn(*s, dtype=torch.bfloat16) * 0.05)(F, D) * (F ** -0.5)),
            "b2": _w((lambda *s: torch.randn(*s, dtype=torch.bfloat16) * 0.05)(D)),
        }
    _B_in = _B_setup()

    return {
        "A_u": _A_in["u"],
        "A_log_A_real": _A_in["log_A_real"],
        "A_A_imag": _A_in["A_imag"],
        "A_C_real": _A_in["C_real"],
        "A_C_imag": _A_in["C_imag"],
        "A_log_dt": _A_in["log_dt"],
        "A_D_skip": _A_in["D_skip"],
        "B_x": _B_in["x"],
        "B_w1": _B_in["w1"],
        "B_b1": _B_in["b1"],
        "B_w2": _B_in["w2"],
        "B_b2": _B_in["b2"],
        "gate_w": _w((lambda *s: torch.randn(*s, dtype=torch.bfloat16) * 0.05)(512) * 16.0),
    }

def reference(A_u, A_log_A_real, A_A_imag, A_C_real, A_C_imag, A_log_dt, A_D_skip, B_x, B_w1, B_b1, B_w2, B_b2, gate_w):
    def _A_ref(u, log_A_real, A_imag, C_real, C_imag, log_dt, D_skip):
        L = u.shape[1]
        dt = torch.exp(log_dt)
        A = -torch.exp(log_A_real) + 1j * A_imag
        C = (C_real + 1j * C_imag) * dt[:, None]
        pos = (lambda x, dt: x.to(dt))(torch.arange(L), log_dt.dtype)
        P = torch.exp((A * dt[:, None])[:, :, None] * pos[None, None, :])
        K = 2.0 * torch.einsum("dn,dnl->dl", C, P).real
        L2 = 2 * L
        u_t = (lambda x, *d: x.permute(*d))(u, 0, 2, 1)
        Kf = (lambda x, *a, **k: torch.fft.rfft(x.float(), *a, **k))(K, L2)
        Uf = (lambda x, *a, **k: torch.fft.rfft(x.float(), *a, **k))(u_t, L2)
        y = (lambda x, *a, **k: torch.fft.irfft(x, *a, **k).to(torch.bfloat16))(Uf * Kf[None, :, :], L2)[:, :, :L]
        y = (lambda x, *d: x.permute(*d))(y, 0, 2, 1)
        return y + u * D_skip[None, None, :]

    def _B_ref(x, w1, b1, w2, b2):
        y = _layernorm(x, axis=-1)
        h = _gelu(torch.einsum("bsd,df->bsf", y, w1) + b1)
        return torch.einsum("bsf,fd->bsd", h, w2) + b2

    x = A_u
    g = _sigmoid((x * gate_w).sum(-1, keepdims=True))
    a = _A_ref(x, A_log_A_real, A_A_imag, A_C_real, A_C_imag, A_log_dt, A_D_skip)
    b = _B_ref(x, B_w1, B_b1, B_w2, B_b2)
    return g * a + (1 - g) * b
```

```asm
; @launch grid=(256,1,1) block=(256,1,1) lds=163840
.amdgcn_target "amdgcn-amd-amdhsa--gfx950"
.text
.globl gated_mix__ssm_conv_s4d__mixer_channel_mlp__prompt_kernel
.p2align 12
.fill 832, 4, 0xbf810000
.p2align 8
.type gated_mix__ssm_conv_s4d__mixer_channel_mlp__prompt_kernel,@function
gated_mix__ssm_conv_s4d__mixer_channel_mlp__prompt_kernel:
    s_load_dwordx16 s[4:19], s[0:1], 0
    s_load_dwordx16 s[20:35], s[0:1], 64
    s_getpc_b64 s[66:67]
    s_cmp_ge_u32 s2, 32
    s_cbranch_scc1 L_NOTOUCH
    v_lshlrev_b32 v3, 7, v0
    global_load_dword v254, v3, s[66:67]
    s_memrealtime s[64:65]
L_NOTOUCH:
    s_lshr_b32 s58, s2, 3
    s_cmp_ge_u32 s58, 32
    s_cbranch_scc1 L_END
    v_lshrrev_b32 v3, 6, v0
    s_lshl_b32 s61, s2, 9
    v_lshl_add_u32 v13, v0, 1, s61
    v_readfirstlane_b32 s56, v3
    v_and_b32 v0, 63, v0
    v_lshrrev_b32 v14, 8, v13
    v_lshlrev_b32 v14, 1, v14
    s_and_b32 s57, s2, 1
    s_bfe_u32 s61, s2, 0x20001
    s_and_b32 s62, s58, 3
    s_lshr_b32 s60, s58, 2
    s_lshl2_add_u32 s59, s61, s62
    s_lshl1_add_u32 s94, s62, s60
    s_lshr_b32 s87, s56, 1
    s_and_b32 s95, s56, 1
    s_lshl_b32 s73, s56, 12
    s_mul_i32 s61, s57, 7
    s_add_u32 s93, s61, s60
    s_sub_u32 s93, s93, 1
    s_xor_b32 s61, s56, s57
    s_xor_b32 s61, s61, 1
    s_lshl2_add_u32 s88, s59, s61
    s_lshl_b32 s88, s88, 15
    s_mul_i32 s89, s56, 57344
    s_lshl_b32 s61, s93, 8
    s_add_u32 s89, s89, s61
    s_mov_b32 s38, 2097152
    s_mov_b32 s39, 0x20000
    s_mov_b32 s42, 1835008
    s_mov_b32 s43, s39
    v_lshrrev_b32 v30, 3, v0
    v_and_b32 v31, 7, v0
    v_lshrrev_b32 v3, 4, v0
    s_lshl_b32 s61, s56, 1
    s_and_b32 s61, s61, 2
    v_bitop3_b32 v31, v31, v3, s61 bitop3:0x96
    v_lshlrev_b32_e64 v31, 4, v31
    v_lshl_add_u32 v16, v30, 10, v31
    s_movk_i32 s61, 7168
    v_xad_u32 v17, v16, 64, s61
    s_movk_i32 s61, 14336
    v_xad_u32 v18, v16, 16, s61
    v_xad_u32 v19, v17, 16, s61
    v_and_b32 v31, 15, v0
    v_lshlrev_b32 v30, 2, v3
    v_xor_b32 v31, v31, v30
    v_lshlrev_b32 v31, 4, v31
    v_mul_u32_u24 v30, 3584, v3
    v_add_u32_e64 v20, v30, v31
    v_add_u32 v21, 13312, v20
    v_add_u32 v22, 26624, v20
    v_add_u32 v23, 39936, v20
    v_and_b32 v36, 15, v0
    v_lshrrev_b32 v37, 4, v0
    s_lshl_b32 s62, s87, 9
    s_add_u32 s62, s62, 49152
    v_xor_b32 v38, v36, v37
    v_lshl_add_u32 v38, v38, 4, s62
    v_lshl_add_u32 v208, v36, 10, v38
    v_sub_u32 v39, 15, v36
    v_cvt_f32_u32 v39, v39
    v_mov_b32 v128, 0
    v_mov_b32 v129, 0
    v_mov_b32 v130, 0
    s_cmp_eq_u32 s95, 0
    s_cselect_b32 s61, 0, -3
    s_cselect_b32 s63, 0, 35
    v_ldexp_f32 v40, v39, s61
    v_rndne_f32 v40, v40
    v_cvt_u32_f32 v40, v40
    v_add_u32 v40, s63, v40
    v_lshlrev_b32 v41, s95, v40
    v_and_b32 v41, 15, v41
    v_xor_b32 v41, v41, v37
    v_lshl_add_u32 v41, v41, 4, s62
    v_lshl_add_u32 v212, v40, 10, v41
    s_cselect_b32 s61, -1, -3
    s_cselect_b32 s63, 16, 38
    v_ldexp_f32 v40, v39, s61
    v_rndne_f32 v40, v40
    v_cvt_u32_f32 v40, v40
    v_add_u32 v40, s63, v40
    v_lshlrev_b32 v41, 1, v40
    v_and_b32 v41, 15, v41
    v_xor_b32 v41, v41, v37
    v_lshl_add_u32 v41, v41, 4, s62
    v_lshl_add_u32 v216, v40, 10, v41
    s_cselect_b32 s61, -2, -3
    s_cselect_b32 s63, 25, 41
    v_ldexp_f32 v40, v39, s61
    v_rndne_f32 v40, v40
    v_cvt_u32_f32 v40, v40
    v_add_u32 v40, s63, v40
    v_lshlrev_b32 v41, 1, v40
    v_and_b32 v41, 15, v41
    v_xor_b32 v41, v41, v37
    v_lshl_add_u32 v41, v41, 4, s62
    v_lshl_add_u32 v220, v40, 10, v41
    s_cselect_b32 s61, -2, -3
    s_cselect_b32 s63, 30, 44
    v_ldexp_f32 v40, v39, s61
    v_rndne_f32 v40, v40
    v_cvt_u32_f32 v40, v40
    v_add_u32 v40, s63, v40
    v_lshlrev_b32 v41, 1, v40
    v_and_b32 v41, 15, v41
    v_xor_b32 v41, v41, v37
    v_lshl_add_u32 v41, v41, 4, s62
    v_lshl_add_u32 v224, v40, 10, v41
    v_xor_b32_e64 v209, 64, v208
    v_xor_b32 v210, 128, v208
    v_xor_b32 v211, 192, v208
    v_xor_b32_e64 v213, 64, v212
    v_xor_b32 v214, 128, v212
    v_xor_b32 v215, 192, v212
    v_xor_b32_e64 v217, 64, v216
    v_xor_b32 v218, 128, v216
    v_xor_b32 v219, 192, v216
    v_xor_b32_e64 v221, 64, v220
    v_xor_b32 v222, 128, v220
    v_xor_b32 v223, 192, v220
    v_xor_b32_e64 v225, 64, v224
    v_xor_b32 v226, 128, v224
    v_xor_b32 v227, 192, v224
    s_waitcnt lgkmcnt(0)
    s_or_b32 s61, s2, s56
    s_cbranch_scc1 L_NONONCE
    s_bitset1_b32 s64, 31
    v_mov_b32_e64 v30, s64
    global_store_dword v14, v30, s[32:33] sc1
L_NONONCE:
    global_load_ushort v240, v13, s[6:7]
    global_load_ushort v241, v13, s[8:9]
    global_load_ushort v242, v13, s[10:11]
    global_load_ushort v243, v13, s[12:13]
    global_load_ushort v244, v14, s[14:15]
    global_load_ushort v245, v14, s[16:17]
    s_mov_b64 s[36:37], s[4:5]
    s_mov_b64 s[40:41], s[20:21]
    s_and_b32 s19, s94, 7
    s_cmp_lg_u32 s60, 0
    s_cbranch_scc1 L_G1
    s_lshl1_add_u32 s93, s59, s57
    s_lshl2_add_u32 s90, s93, s56
    s_lshl_b32 s90, s90, 14
    s_mul_i32 s91, s56, 16640
    v_lshlrev_b32 v1, 4, v0
    s_add_u32 m0, s73, 0
    s_lshl_b32 s1, s19, 7
    s_add_u32 s1, s88, s1
    buffer_load_dwordx4 v16, s[36:39], s1 offen offset:0 lds
    buffer_load_dwordx4 v17, s[36:39], s1 offen offset:1024 lds
    buffer_load_dwordx4 v18, s[36:39], s1 offen offset:2048 lds
    buffer_load_dwordx4 v19, s[36:39], s1 offen offset:3072 lds
    s_add_u32 m0, s91, 16384
    s_nop 0
    buffer_load_dwordx4 v1, s[36:39], s90 offen offset:0 lds
    s_add_u32 m0, m0, 16
    s_nop 0
    buffer_load_dwordx4 v1, s[36:39], s90 offen offset:1024 lds
    s_add_u32 m0, m0, 16
    s_nop 0
    buffer_load_dwordx4 v1, s[36:39], s90 offen offset:2048 lds
    s_add_u32 m0, m0, 16
    s_nop 0
    buffer_load_dwordx4 v1, s[36:39], s90 offen offset:3072 lds
    s_branch L_SERVICE
L_G1:
    s_add_u32 m0, s73, 131072
    s_mul_i32 s0, s19, 229376
    s_add_u32 s0, s89, s0
    buffer_load_dwordx4 v20, s[40:43], s0 offen offset:0 lds
    buffer_load_dwordx4 v21, s[40:43], s0 offen offset:1024 lds
    buffer_load_dwordx4 v22, s[40:43], s0 offen offset:2048 lds
    buffer_load_dwordx4 v23, s[40:43], s0 offen offset:3072 lds
    s_add_u32 m0, s73, 0
    s_lshl_b32 s1, s19, 7
    s_add_u32 s1, s88, s1
    buffer_load_dwordx4 v16, s[36:39], s1 offen offset:0 lds
    s_mov_b64 s[44:45], s[24:25]
    s_mov_b64 s[46:47], s[42:43]
    s_mov_b64 s[48:49], s[34:35]
    s_mov_b32 s50, 268435456
    s_mov_b32 s51, s39
    s_mov_b64 s[52:53], s[30:31]
    s_mov_b64 s[54:55], s[38:39]
    v_lshlrev_b32 v1, 4, v0
    v_mov_b32 v12, 0
    s_lshl2_add_u32 s81, s2, s56
    s_lshl_b32 s81, s81, 11
    s_add_u32 s81, s81, 10485760
    buffer_load_dwordx4 v17, s[36:39], s1 offen offset:1024 lds
    s_xor_b32 s82, s60, 3
    s_lshl1_add_u32 s83, s59, s87
    s_lshl_b32 s72, s87, 15
    s_lshl_b32 s61, s82, 7
    s_add_u32 s72, s72, s61
    s_mul_i32 s62, s57, 14
    s_add_u32 s62, s62, s95
    s_lshl_b32 s62, s62, 12
    s_max_u32 s61, s60, 1
    s_sub_u32 s61, s61, 1
    s_lshl_b32 s74, s61, 13
    s_add_u32 s74, s74, s62
    buffer_load_dwordx4 v18, s[36:39], s1 offen offset:2048 lds
    s_and_b32 s63, s59, 3
    s_mul_i32 s63, s63, 3
    s_lshr_b32 s63, s63, 1
    s_lshl_b32 s63, s63, 2
    s_mov_b32 s64, 0x21654321
    s_movk_i32 s65, 0x6543
    s_lshr_b64 s[64:65], s[64:65], s63
    s_mul_i32 s61, s61, 0x111111
    s_add_u32 s61, s61, s64
    s_add_u32 s63, s61, 0x111111
    s_lshr_b32 s63, s63, 3
    s_and_b32 s63, s63, 0x111111
    buffer_load_dwordx4 v19, s[36:39], s1 offen offset:3072 lds
    s_add_u32 s61, s61, s63
    s_bfe_u32 s75, s61, 0x30000
    s_lshl_b32 s75, s75, 13
    s_add_u32 s75, s75, s62
    s_bfe_u32 s76, s61, 0x30004
    s_lshl_b32 s76, s76, 13
    s_add_u32 s76, s76, s62
    s_bfe_u32 s77, s61, 0x30008
    s_lshl_b32 s77, s77, 13
    s_add_u32 s77, s77, s62
    s_bfe_u32 s78, s61, 0x3000c
    s_lshl_b32 s78, s78, 13
    s_add_u32 s78, s78, s62
    s_bfe_u32 s79, s61, 0x30010
    s_lshl_b32 s79, s79, 13
    s_add_u32 s79, s79, s62
    s_bfe_u32 s80, s61, 0x30014
    s_lshl_b32 s80, s80, 13
    s_add_u32 s80, s80, s62
    s_mul_i32 s85, s83, 229376
    s_add_u32 s86, s85, 114688
    v_lshrrev_b32 v44, 3, v0
    v_and_b32_e64 v45, 7, v0
    v_bfe_u32 v46, v0, 4, 1
    v_lshlrev_b32 v47, 2, v46
    v_xor_b32 v47, v47, v45
    v_lshlrev_b32_e64 v47, 4, v47
    v_lshl_add_u32 v4, v44, 10, v47
    v_add_u32 v5, 7168, v4
    v_add_u32 v6, 14336, v4
    v_add_u32 v7, 21504, v4
    v_bfe_u32 v44, v0, 2, 2
    v_lshrrev_b32_e64 v45, 5, v0
    v_lshl_add_u32 v45, v45, 2, v44
    v_lshlrev_b32_e64 v45, 7, v45
    v_lshl_add_u32 v45, v46, 5, v45
    v_and_b32_e64 v46, 3, v0
    v_lshl_add_u32 v45, v46, 3, v45
    v_lshrrev_b32_e64 v44, 1, v44
    v_lshl_add_u32 v45, v44, 6, v45
    s_mul_i32 s61, s95, 4160
    v_xor_b32 v9, s61, v45
    v_xor_b32 v8, 64, v9
    v_add_u32 v10, 98304, v8
    v_add_u32 v11, 98304, v9
    v_and_b32 v44, 3, v0
    v_lshlrev_b32 v45, 1, v44
    v_sub_u32 v45, s60, v45
    v_and_b32 v45, 7, v45
    v_lshl_or_b32 v44, v45, 2, v44
    v_bfe_u32 v45, v0, 2, 2
    v_lshl_or_b32 v44, v44, 2, v45
    s_bfe_u32 s61, s58, 0x10001
    v_lshl_or_b32 v14, v44, 1, s61
    v_lshlrev_b32_e64 v14, 7, v14
    v_add_u32 v14, 14811136, v14
    s_lshl_b32 s61, s56, 2
    s_bfm_b64 s[14:15], 4, s61
    v_cndmask_b32 v14, -1, v14, s[14:15]
    s_lshl_b32 s63, s87, 13
    v_and_b32 v30, 31, v0
    v_bfe_u32 v31, v0, 1, 3
    v_lshrrev_b32 v3, 5, v0
    v_lshrrev_b32 v24, 4, v30
    v_bitop3_b32 v31, v31, v3, v24 bitop3:0x96
    v_lshlrev_b32_e64 v31, 4, v31
    v_lshl_add_u32 v31, v30, 7, v31
    v_add_u32 v24, s63, v31
    v_xor_b32 v25, 32, v24
    v_xor_b32_e64 v26, 64, v24
    v_xor_b32 v27, 96, v24
    v_bfe_u32 v30, v0, 2, 2
    v_lshl_add_u32 v31, v3, 3, v30
    v_lshlrev_b32 v31, 8, v31
    s_lshl_b32 s63, s95, 7
    v_lshlrev_b32 v30, 6, v30
    v_xor_b32 v30, s63, v30
    v_add_u32_e64 v31, v31, v30
    v_bfe_u32 v30, v0, 4, 1
    v_lshl_add_u32 v31, v30, 5, v31
    v_and_b32_e64 v30, 3, v0
    v_lshl_add_u32 v31, v30, 3, v31
    v_add_u32 v28, 114688, v31
    v_xor_b32 v29, 64, v28
    v_and_b32 v236, 7, v0
    v_lshrrev_b32 v233, 1, v236
    v_and_b32 v234, 1, v0
    v_lshl_or_b32 v233, v234, 2, v233
    v_lshrrev_b32 v234, 5, v0
    s_lshl1_add_u32 s61, s57, s95
    s_lshl_b32 s62, s61, 1
    v_bitop3_b32 v233, v233, v234, s62 bitop3:0x96
    v_bfe_u32 v234, v0, 3, 2
    v_lshl_or_b32 v233, v233, 2, v234
    v_lshl_add_u32 v234, s87, 3, v236
    v_lshlrev_b32 v234, 10, v234
    v_lshl_add_u32 v232, v233, 2, v234
    v_xor_b32 v233, 16, v232
    v_xor_b32 v234, 32, v232
    v_xor_b32 v235, 48, v232
    s_lshl2_add_u32 s6, s19, s61
    s_lshl_b32 s61, s56, 8
    s_add_u32 s61, s61, 49152
    v_lshl_add_u32 v112, v0, 2, s61
    v_xor_b32 v113, 16, v112
    v_xor_b32 v114, 32, v112
    v_xor_b32 v115, 48, v112
    v_xor_b32_e64 v116, 64, v112
    v_xor_b32 v117, 80, v112
    v_xor_b32 v118, 96, v112
    v_xor_b32 v119, 112, v112
    v_xor_b32 v120, 128, v112
    v_xor_b32 v121, 144, v112
    v_xor_b32 v122, 160, v112
    v_xor_b32 v123, 176, v112
    v_xor_b32 v124, 192, v112
    v_xor_b32 v125, 208, v112
    v_xor_b32 v126, 224, v112
    v_xor_b32 v127, 240, v112
    s_lshl1_add_u32 s61, s59, s87
    s_lshl_b32 s8, s2, 7
    s_add_u32 s8, s8, 14811136
    s_lshl_b32 s62, s56, 28
    s_add_u32 s8, s8, s62
    s_lshl_b32 s6, s6, 9
    s_add_u32 s6, s6, s61
    s_lshl_b32 s6, s6, 7
    s_add_u32 s6, s6, 8388608
    s_add_u32 s7, s6, 4096
    s_lshl_b32 s61, s57, 2
    s_xor_b32 s61, s61, 4
    v_xor_b32 v236, s61, v236
    v_lshrrev_b32 v237, 3, v0
    v_lshlrev_b32 v237, 13, v237
    v_lshl_add_u32 v236, v236, 4, v237
    s_mov_b32 s10, 0x05040100
    s_mov_b32 s11, 0x07060302
    s_mov_b64 exec, 0
    s_cmp_eq_u32 s56, 0
    s_cbranch_scc1 IW0
    s_cmp_eq_u32 s56, 1
    s_cbranch_scc1 IW1
    s_cmp_eq_u32 s56, 2
    s_cbranch_scc1 IW2
    s_branch IW3
IWBACK:
    s_mov_b64 exec, -1
    s_lshl4_add_u32 s61, s95, 48
    v_cmp_eq_u32 vcc, s61, v0
    s_waitcnt vmcnt(8)
    v_lshlrev_b32 v240, 16, v240
    v_lshlrev_b32 v244, 16, v244
    v_mul_f32 v240, 0x3fb8aa3b, v240
    v_mul_f32 v244, 0x3fb8aa3b, v244
    v_exp_f32 v240, v240
    v_exp_f32 v244, v244
    v_lshlrev_b32 v241, 16, v241
    v_lshlrev_b32 v242, 16, v242
    v_lshlrev_b32_e64 v243, 16, v243
    v_cvt_pk_bf16_f32 v240, v244, v240
    v_lshlrev_b32_e64 v244, 16, v240
    v_and_b32 v240, 0xffff0000, v240
    v_mul_f32 v240, v240, v244
    v_mul_f32 v241, v241, v244
    v_mul_f32 v240, 0xbfb8aa3b, v240
    v_mul_f32 v241, 0.15915494, v241
    v_add_f32 v244, v244, v244
    v_mul_f32_e64 v82, v242, v244
    v_mul_f32 v83, -v243, v244
    v_mul_f32 v90, 0x43800000, v240
    v_mul_f32 v91, 0x43800000, v241
    v_fract_f32 v241, v241
    v_fract_f32 v91, v91
    v_exp_f32 v240, v240
    v_exp_f32 v90, v90
    v_cos_f32 v50, v241
    v_sin_f32 v51, v241
    v_cos_f32 v48, v91
    v_sin_f32 v49, v91
    v_mov_b32 v144, 0x3f80
    v_lshlrev_b32 v245, 16, v245
    v_cndmask_b32 v131, 0, v245, vcc
    v_pk_mul_f32 v[50:51], v[50:51], v[240:241] op_sel_hi:[1,0]
    v_pk_mul_f32 v[48:49], v[48:49], v[90:91] op_sel_hi:[1,0]
    v_cvt_pk_bf16_f32 v145, v50, v51
    v_pk_mul_f32 v[90:91], v[50:51], v[50:51] op_sel_hi:[1,0]
    v_pk_fma_f32 v[52:53], v[50:51], v[50:51], v[90:91] op_sel:[1,1,0] op_sel_hi:[0,1,1] neg_lo:[1,0,0]
    v_cvt_pk_bf16_f32 v146, v52, v53
    v_pk_mul_f32 v[90:91], v[52:53], v[50:51] op_sel_hi:[1,0]
    v_pk_fma_f32 v[54:55], v[52:53], v[50:51], v[90:91] op_sel:[1,1,0] op_sel_hi:[0,1,1] neg_lo:[1,0,0]
    v_cvt_pk_bf16_f32 v147, v54, v55
    v_pk_mul_f32 v[90:91], v[54:55], v[50:51] op_sel_hi:[1,0]
    v_pk_fma_f32 v[56:57], v[54:55], v[50:51], v[90:91] op_sel:[1,1,0] op_sel_hi:[0,1,1] neg_lo:[1,0,0]
    v_cvt_pk_bf16_f32 v148, v56, v57
    v_pk_mul_f32 v[90:91], v[56:57], v[50:51] op_sel_hi:[1,0]
    v_pk_fma_f32 v[58:59], v[56:57], v[50:51], v[90:91] op_sel:[1,1,0] op_sel_hi:[0,1,1] neg_lo:[1,0,0]
    v_cvt_pk_bf16_f32 v149, v58, v59
    v_pk_mul_f32 v[90:91], v[58:59], v[50:51] op_sel_hi:[1,0]
    v_pk_fma_f32 v[60:61], v[58:59], v[50:51], v[90:91] op_sel:[1,1,0] op_sel_hi:[0,1,1] neg_lo:[1,0,0]
    v_cvt_pk_bf16_f32 v150, v60, v61
    v_pk_mul_f32 v[90:91], v[60:61], v[50:51] op_sel_hi:[1,0]
    v_pk_fma_f32 v[62:63], v[60:61], v[50:51], v[90:91] op_sel:[1,1,0] op_sel_hi:[0,1,1] neg_lo:[1,0,0]
    v_cvt_pk_bf16_f32 v151, v62, v63
    v_pk_mul_f32 v[90:91], v[62:63], v[50:51] op_sel_hi:[1,0]
    v_pk_fma_f32 v[64:65], v[62:63], v[50:51], v[90:91] op_sel:[1,1,0] op_sel_hi:[0,1,1] neg_lo:[1,0,0]
    v_cvt_pk_bf16_f32 v152, v64, v65
    v_pk_mul_f32 v[90:91], v[64:65], v[50:51] op_sel_hi:[1,0]
    v_pk_fma_f32 v[66:67], v[64:65], v[50:51], v[90:91] op_sel:[1,1,0] op_sel_hi:[0,1,1] neg_lo:[1,0,0]
    v_cvt_pk_bf16_f32 v153, v66, v67
    s_add_u32 m0, s73, 147456
    s_xor_b32 s0, s19, 1
    s_mul_i32 s0, s0, 229376
    s_add_u32 s0, s89, s0
    buffer_load_dwordx4 v20, s[40:43], s0 offen offset:0 lds
    v_pk_mul_f32 v[90:91], v[66:67], v[50:51] op_sel_hi:[1,0]
    v_pk_fma_f32 v[68:69], v[66:67], v[50:51], v[90:91] op_sel:[1,1,0] op_sel_hi:[0,1,1] neg_lo:[1,0,0]
    v_cvt_pk_bf16_f32 v154, v68, v69
    v_pk_mul_f32 v[90:91], v[68:69], v[50:51] op_sel_hi:[1,0]
    v_pk_fma_f32 v[70:71], v[68:69], v[50:51], v[90:91] op_sel:[1,1,0] op_sel_hi:[0,1,1] neg_lo:[1,0,0]
    v_cvt_pk_bf16_f32 v155, v70, v71
    v_pk_mul_f32 v[90:91], v[70:71], v[50:51] op_sel_hi:[1,0]
    v_pk_fma_f32 v[72:73], v[70:71], v[50:51], v[90:91] op_sel:[1,1,0] op_sel_hi:[0,1,1] neg_lo:[1,0,0]
    v_cvt_pk_bf16_f32 v156, v72, v73
    v_pk_mul_f32 v[90:91], v[72:73], v[50:51] op_sel_hi:[1,0]
    v_pk_fma_f32 v[74:75], v[72:73], v[50:51], v[90:91] op_sel:[1,1,0] op_sel_hi:[0,1,1] neg_lo:[1,0,0]
    v_cvt_pk_bf16_f32 v157, v74, v75
    v_pk_mul_f32 v[90:91], v[74:75], v[50:51] op_sel_hi:[1,0]
    v_pk_fma_f32 v[76:77], v[74:75], v[50:51], v[90:91] op_sel:[1,1,0] op_sel_hi:[0,1,1] neg_lo:[1,0,0]
    v_cvt_pk_bf16_f32 v158, v76, v77
    v_pk_mul_f32 v[90:91], v[76:77], v[50:51] op_sel_hi:[1,0]
    v_pk_fma_f32 v[78:79], v[76:77], v[50:51], v[90:91] op_sel:[1,1,0] op_sel_hi:[0,1,1] neg_lo:[1,0,0]
    v_cvt_pk_bf16_f32 v159, v78, v79
    v_pk_mul_f32 v[90:91], v[78:79], v[50:51] op_sel_hi:[1,0]
    v_pk_fma_f32 v[80:81], v[78:79], v[50:51], v[90:91] op_sel:[1,1,0] op_sel_hi:[0,1,1] neg_lo:[1,0,0]
    v_cvt_pk_bf16_f32 v191, v82, v83
    buffer_load_dwordx4 v21, s[40:43], s0 offen offset:1024 lds
    ds_write2st64_b32 v112, v144, v191 offset0:0 offset1:188
    v_pk_mul_f32 v[90:91], v[82:83], v[80:81] op_sel_hi:[1,0]
    v_pk_fma_f32 v[84:85], v[82:83], v[80:81], v[90:91] op_sel:[1,1,0] op_sel_hi:[0,1,1] neg_hi:[1,0,0]
    v_cvt_pk_bf16_f32 v192, v84, v85
    ds_write2st64_b32 v113, v145, v192 offset0:4 offset1:192
    v_pk_mul_f32 v[90:91], v[84:85], v[80:81] op_sel_hi:[1,0]
    v_pk_fma_f32 v[82:83], v[84:85], v[80:81], v[90:91] op_sel:[1,1,0] op_sel_hi:[0,1,1] neg_hi:[1,0,0]
    v_cvt_pk_bf16_f32 v193, v82, v83
    ds_write2st64_b32 v114, v146, v193 offset0:8 offset1:196
    v_pk_mul_f32 v[90:91], v[82:83], v[80:81] op_sel_hi:[1,0]
    v_pk_fma_f32 v[84:85], v[82:83], v[80:81], v[90:91] op_sel:[1,1,0] op_sel_hi:[0,1,1] neg_hi:[1,0,0]
    v_cvt_pk_bf16_f32 v194, v84, v85
    ds_write2st64_b32 v115, v147, v194 offset0:12 offset1:200
    v_pk_mul_f32 v[90:91], v[84:85], v[80:81] op_sel_hi:[1,0]
    v_pk_fma_f32 v[82:83], v[84:85], v[80:81], v[90:91] op_sel:[1,1,0] op_sel_hi:[0,1,1] neg_hi:[1,0,0]
    v_cvt_pk_bf16_f32 v195, v82, v83
    ds_write2st64_b32 v116, v148, v195 offset0:16 offset1:204
    v_pk_mul_f32 v[90:91], v[82:83], v[80:81] op_sel_hi:[1,0]
    v_pk_fma_f32 v[84:85], v[82:83], v[80:81], v[90:91] op_sel:[1,1,0] op_sel_hi:[0,1,1] neg_hi:[1,0,0]
    v_cvt_pk_bf16_f32 v196, v84, v85
    ds_write2st64_b32 v117, v149, v196 offset0:20 offset1:208
    buffer_load_dwordx4 v22, s[40:43], s0 offen offset:2048 lds
    v_pk_mul_f32 v[90:91], v[84:85], v[80:81] op_sel_hi:[1,0]
    v_pk_fma_f32 v[82:83], v[84:85], v[80:81], v[90:91] op_sel:[1,1,0] op_sel_hi:[0,1,1] neg_hi:[1,0,0]
    v_cvt_pk_bf16_f32 v197, v82, v83
    ds_write2st64_b32 v118, v150, v197 offset0:24 offset1:212
    v_pk_mul_f32 v[90:91], v[82:83], v[80:81] op_sel_hi:[1,0]
    v_pk_fma_f32 v[84:85], v[82:83], v[80:81], v[90:91] op_sel:[1,1,0] op_sel_hi:[0,1,1] neg_hi:[1,0,0]
    v_cvt_pk_bf16_f32 v198, v84, v85
    ds_write2st64_b32 v119, v151, v198 offset0:28 offset1:216
    v_pk_mul_f32 v[90:91], v[84:85], v[80:81] op_sel_hi:[1,0]
    v_pk_fma_f32 v[82:83], v[84:85], v[80:81], v[90:91] op_sel:[1,1,0] op_sel_hi:[0,1,1] neg_hi:[1,0,0]
    v_cvt_pk_bf16_f32 v199, v82, v83
    ds_write2st64_b32 v120, v152, v199 offset0:32 offset1:220
    v_pk_mul_f32 v[90:91], v[82:83], v[80:81] op_sel_hi:[1,0]
    v_pk_fma_f32 v[84:85], v[82:83], v[80:81], v[90:91] op_sel:[1,1,0] op_sel_hi:[0,1,1] neg_hi:[1,0,0]
    v_cvt_pk_bf16_f32 v200, v84, v85
    ds_write2st64_b32 v121, v153, v200 offset0:36 offset1:224
    v_pk_mul_f32 v[90:91], v[84:85], v[80:81] op_sel_hi:[1,0]
    v_pk_fma_f32 v[82:83], v[84:85], v[80:81], v[90:91] op_sel:[1,1,0] op_sel_hi:[0,1,1] neg_hi:[1,0,0]
    v_cvt_pk_bf16_f32 v201, v82, v83
    ds_write2st64_b32 v122, v154, v201 offset0:40 offset1:228
    v_pk_mul_f32 v[90:91], v[82:83], v[80:81] op_sel_hi:[1,0]
    buffer_load_dwordx4 v23, s[40:43], s0 offen offset:3072 lds
    v_pk_fma_f32 v[84:85], v[82:83], v[80:81], v[90:91] op_sel:[1,1,0] op_sel_hi:[0,1,1] neg_hi:[1,0,0]
    v_cvt_pk_bf16_f32 v202, v84, v85
    ds_write2st64_b32 v123, v155, v202 offset0:44 offset1:232
    v_pk_mul_f32 v[90:91], v[84:85], v[80:81] op_sel_hi:[1,0]
    v_pk_fma_f32 v[82:83], v[84:85], v[80:81], v[90:91] op_sel:[1,1,0] op_sel_hi:[0,1,1] neg_hi:[1,0,0]
    v_cvt_pk_bf16_f32 v203, v82, v83
    ds_write2st64_b32 v124, v156, v203 offset0:48 offset1:236
    v_pk_mul_f32 v[90:91], v[82:83], v[80:81] op_sel_hi:[1,0]
    v_pk_fma_f32 v[84:85], v[82:83], v[80:81], v[90:91] op_sel:[1,1,0] op_sel_hi:[0,1,1] neg_hi:[1,0,0]
    v_cvt_pk_bf16_f32 v204, v84, v85
    ds_write2st64_b32 v125, v157, v204 offset0:52 offset1:240
    v_pk_mul_f32 v[90:91], v[84:85], v[80:81] op_sel_hi:[1,0]
    v_pk_fma_f32 v[82:83], v[84:85], v[80:81], v[90:91] op_sel:[1,1,0] op_sel_hi:[0,1,1] neg_hi:[1,0,0]
    v_cvt_pk_bf16_f32 v205, v82, v83
    ds_write2st64_b32 v126, v158, v205 offset0:56 offset1:244
    v_pk_mul_f32 v[90:91], v[82:83], v[80:81] op_sel_hi:[1,0]
    v_pk_fma_f32 v[84:85], v[82:83], v[80:81], v[90:91] op_sel:[1,1,0] op_sel_hi:[0,1,1] neg_hi:[1,0,0]
    v_cvt_pk_bf16_f32 v206, v84, v85
    ds_write2st64_b32 v127, v159, v206 offset0:60 offset1:248
    v_cvt_pk_bf16_f32 v160, v48, v49
    v_pk_mul_f32 v[90:91], v[48:49], v[52:53] op_sel_hi:[1,0]
    v_pk_fma_f32 v[82:83], v[48:49], v[52:53], v[90:91] op_sel:[1,1,0] op_sel_hi:[0,1,1] neg_lo:[1,0,0]
    v_cvt_pk_bf16_f32 v161, v82, v83
    v_pk_mul_f32 v[90:91], v[48:49], v[56:57] op_sel_hi:[1,0]
    v_pk_fma_f32 v[82:83], v[48:49], v[56:57], v[90:91] op_sel:[1,1,0] op_sel_hi:[0,1,1] neg_lo:[1,0,0]
    v_cvt_pk_bf16_f32 v162, v82, v83
    v_pk_mul_f32 v[90:91], v[48:49], v[60:61] op_sel_hi:[1,0]
    v_pk_fma_f32 v[82:83], v[48:49], v[60:61], v[90:91] op_sel:[1,1,0] op_sel_hi:[0,1,1] neg_lo:[1,0,0]
    v_cvt_pk_bf16_f32 v163, v82, v83
    v_pk_mul_f32 v[90:91], v[48:49], v[64:65] op_sel_hi:[1,0]
    v_pk_fma_f32 v[82:83], v[48:49], v[64:65], v[90:91] op_sel:[1,1,0] op_sel_hi:[0,1,1] neg_lo:[1,0,0]
    v_cvt_pk_bf16_f32 v164, v82, v83
    v_pk_mul_f32 v[90:91], v[48:49], v[68:69] op_sel_hi:[1,0]
    v_pk_fma_f32 v[82:83], v[48:49], v[68:69], v[90:91] op_sel:[1,1,0] op_sel_hi:[0,1,1] neg_lo:[1,0,0]
    v_cvt_pk_bf16_f32 v165, v82, v83
    v_pk_mul_f32 v[90:91], v[48:49], v[72:73] op_sel_hi:[1,0]
    v_pk_fma_f32 v[82:83], v[48:49], v[72:73], v[90:91] op_sel:[1,1,0] op_sel_hi:[0,1,1] neg_lo:[1,0,0]
    v_cvt_pk_bf16_f32 v166, v82, v83
    v_pk_mul_f32 v[90:91], v[48:49], v[76:77] op_sel_hi:[1,0]
    v_pk_fma_f32 v[82:83], v[48:49], v[76:77], v[90:91] op_sel:[1,1,0] op_sel_hi:[0,1,1] neg_lo:[1,0,0]
    v_cvt_pk_bf16_f32 v167, v82, v83
    v_pk_mul_f32 v[90:91], v[48:49], v[80:81] op_sel_hi:[1,0]
    s_lshl_b32 s61, s57, 5
    s_add_u32 s61, s61, s58
    s_lshl2_add_u32 s61, s61, s56
    s_mul_i32 s61, s61, 7168
    v_lshlrev_b32 v3, 10, v0
    s_mov_b64 exec, 0x7f
    buffer_load_dword v255, v3, s[44:47], s61 offen offset:384
    s_mov_b64 exec, -1
    v_pk_fma_f32 v[82:83], v[48:49], v[80:81], v[90:91] op_sel:[1,1,0] op_sel_hi:[0,1,1] neg_lo:[1,0,0]
    v_cvt_pk_bf16_f32 v168, v82, v83
    ds_write2st64_b32 v112, v160, v168 offset0:64 offset1:96
    v_pk_mul_f32 v[90:91], v[48:49], v[48:49] op_sel_hi:[1,0]
    v_pk_fma_f32 v[86:87], v[48:49], v[48:49], v[90:91] op_sel:[1,1,0] op_sel_hi:[0,1,1] neg_lo:[1,0,0]
    v_cvt_pk_bf16_f32 v169, v86, v87
    ds_write2st64_b32 v114, v161, v169 offset0:68 offset1:100
    v_pk_mul_f32 v[90:91], v[86:87], v[56:57] op_sel_hi:[1,0]
    v_pk_fma_f32 v[82:83], v[86:87], v[56:57], v[90:91] op_sel:[1,1,0] op_sel_hi:[0,1,1] neg_lo:[1,0,0]
    v_cvt_pk_bf16_f32 v170, v82, v83
    ds_write2st64_b32 v116, v162, v170 offset0:72 offset1:104
    v_pk_mul_f32 v[90:91], v[86:87], v[64:65] op_sel_hi:[1,0]
    v_pk_fma_f32 v[82:83], v[86:87], v[64:65], v[90:91] op_sel:[1,1,0] op_sel_hi:[0,1,1] neg_lo:[1,0,0]
    v_cvt_pk_bf16_f32 v171, v82, v83
    ds_write2st64_b32 v118, v163, v171 offset0:76 offset1:108
    v_pk_mul_f32 v[90:91], v[86:87], v[72:73] op_sel_hi:[1,0]
    v_pk_fma_f32 v[82:83], v[86:87], v[72:73], v[90:91] op_sel:[1,1,0] op_sel_hi:[0,1,1] neg_lo:[1,0,0]
    v_cvt_pk_bf16_f32 v172, v82, v83
    ds_write2st64_b32 v120, v164, v172 offset0:80 offset1:112
    v_pk_mul_f32 v[90:91], v[86:87], v[80:81] op_sel_hi:[1,0]
    v_pk_fma_f32 v[82:83], v[86:87], v[80:81], v[90:91] op_sel:[1,1,0] op_sel_hi:[0,1,1] neg_lo:[1,0,0]
    s_add_u32 m0, s73, 16384
    s_xor_b32 s1, s1, 128
    buffer_load_dwordx4 v16, s[36:39], s1 offen offset:0 lds
    v_cvt_pk_bf16_f32 v173, v82, v83
    ds_write2st64_b32 v122, v165, v173 offset0:84 offset1:116
    v_pk_mul_f32 v[90:91], v[86:87], v[48:49] op_sel_hi:[1,0]
    v_pk_fma_f32 v[88:89], v[86:87], v[48:49], v[90:91] op_sel:[1,1,0] op_sel_hi:[0,1,1] neg_lo:[1,0,0]
    v_cvt_pk_bf16_f32 v174, v88, v89
    ds_write2st64_b32 v124, v166, v174 offset0:88 offset1:120
    v_pk_mul_f32 v[90:91], v[88:89], v[56:57] op_sel_hi:[1,0]
    v_pk_fma_f32 v[82:83], v[88:89], v[56:57], v[90:91] op_sel:[1,1,0] op_sel_hi:[0,1,1] neg_lo:[1,0,0]
    v_cvt_pk_bf16_f32 v175, v82, v83
    ds_write2st64_b32 v126, v167, v175 offset0:92 offset1:124
    v_pk_mul_f32 v[90:91], v[88:89], v[64:65] op_sel_hi:[1,0]
    v_pk_fma_f32 v[82:83], v[88:89], v[64:65], v[90:91] op_sel:[1,1,0] op_sel_hi:[0,1,1] neg_lo:[1,0,0]
    v_cvt_pk_bf16_f32 v176, v82, v83
    v_pk_mul_f32 v[90:91], v[88:89], v[72:73] op_sel_hi:[1,0]
    v_pk_fma_f32 v[82:83], v[88:89], v[72:73], v[90:91] op_sel:[1,1,0] op_sel_hi:[0,1,1] neg_lo:[1,0,0]
    v_cvt_pk_bf16_f32 v177, v82, v83
    v_pk_mul_f32 v[90:91], v[88:89], v[80:81] op_sel_hi:[1,0]
    v_pk_fma_f32 v[82:83], v[88:89], v[80:81], v[90:91] op_sel:[1,1,0] op_sel_hi:[0,1,1] neg_lo:[1,0,0]
    v_cvt_pk_bf16_f32 v178, v82, v83
    v_pk_mul_f32 v[90:91], v[88:89], v[48:49] op_sel_hi:[1,0]
    v_pk_fma_f32 v[86:87], v[88:89], v[48:49], v[90:91] op_sel:[1,1,0] op_sel_hi:[0,1,1] neg_lo:[1,0,0]
    buffer_load_dwordx4 v17, s[36:39], s1 offen offset:1024 lds
    v_cvt_pk_bf16_f32 v179, v86, v87
    v_pk_mul_f32 v[90:91], v[86:87], v[64:65] op_sel_hi:[1,0]
    v_pk_fma_f32 v[82:83], v[86:87], v[64:65], v[90:91] op_sel:[1,1,0] op_sel_hi:[0,1,1] neg_lo:[1,0,0]
    v_cvt_pk_bf16_f32 v180, v82, v83
    v_pk_mul_f32 v[90:91], v[86:87], v[80:81] op_sel_hi:[1,0]
    v_pk_fma_f32 v[82:83], v[86:87], v[80:81], v[90:91] op_sel:[1,1,0] op_sel_hi:[0,1,1] neg_lo:[1,0,0]
    v_cvt_pk_bf16_f32 v181, v82, v83
    v_pk_mul_f32 v[90:91], v[86:87], v[48:49] op_sel_hi:[1,0]
    v_pk_fma_f32 v[88:89], v[86:87], v[48:49], v[90:91] op_sel:[1,1,0] op_sel_hi:[0,1,1] neg_lo:[1,0,0]
    v_cvt_pk_bf16_f32 v182, v88, v89
    v_pk_mul_f32 v[90:91], v[88:89], v[64:65] op_sel_hi:[1,0]
    v_pk_fma_f32 v[82:83], v[88:89], v[64:65], v[90:91] op_sel:[1,1,0] op_sel_hi:[0,1,1] neg_lo:[1,0,0]
    v_cvt_pk_bf16_f32 v183, v82, v83
    ds_write_b32 v126, v183 offset:39936
    v_pk_mul_f32 v[90:91], v[88:89], v[80:81] op_sel_hi:[1,0]
    v_pk_fma_f32 v[82:83], v[88:89], v[80:81], v[90:91] op_sel:[1,1,0] op_sel_hi:[0,1,1] neg_lo:[1,0,0]
    v_cvt_pk_bf16_f32 v184, v82, v83
    ds_write2st64_b32 v112, v176, v184 offset0:128 offset1:160
    v_pk_mul_f32 v[90:91], v[88:89], v[48:49] op_sel_hi:[1,0]
    v_pk_fma_f32 v[86:87], v[88:89], v[48:49], v[90:91] op_sel:[1,1,0] op_sel_hi:[0,1,1] neg_lo:[1,0,0]
    v_cvt_pk_bf16_f32 v185, v86, v87
    buffer_load_dwordx4 v18, s[36:39], s1 offen offset:2048 lds
    ds_write2st64_b32 v114, v177, v185 offset0:132 offset1:164
    v_pk_mul_f32 v[90:91], v[86:87], v[64:65] op_sel_hi:[1,0]
    v_pk_fma_f32 v[82:83], v[86:87], v[64:65], v[90:91] op_sel:[1,1,0] op_sel_hi:[0,1,1] neg_lo:[1,0,0]
    v_cvt_pk_bf16_f32 v186, v82, v83
    ds_write2st64_b32 v116, v178, v186 offset0:136 offset1:168
    v_pk_mul_f32 v[90:91], v[86:87], v[80:81] op_sel_hi:[1,0]
    v_pk_fma_f32 v[82:83], v[86:87], v[80:81], v[90:91] op_sel:[1,1,0] op_sel_hi:[0,1,1] neg_lo:[1,0,0]
    v_cvt_pk_bf16_f32 v187, v82, v83
    ds_write2st64_b32 v118, v179, v187 offset0:140 offset1:172
    v_pk_mul_f32 v[90:91], v[86:87], v[48:49] op_sel_hi:[1,0]
IW0:
    s_cbranch_execz IWBACK
    s_nop 0
    v_pk_fma_f32 v[88:89], v[86:87], v[48:49], v[90:91] op_sel:[1,1,0] op_sel_hi:[0,1,1] neg_lo:[1,0,0]
    v_cvt_pk_bf16_f32 v188, v88, v89
    ds_write2st64_b32 v120, v180, v188 offset0:144 offset1:176
    v_pk_mul_f32 v[90:91], v[88:89], v[64:65] op_sel_hi:[1,0]
    v_pk_fma_f32 v[82:83], v[88:89], v[64:65], v[90:91] op_sel:[1,1,0] op_sel_hi:[0,1,1] neg_lo:[1,0,0]
    v_cvt_pk_bf16_f32 v189, v82, v83
    ds_write2st64_b32 v122, v181, v189 offset0:148 offset1:180
    v_pk_mul_f32 v[90:91], v[88:89], v[80:81] op_sel_hi:[1,0]
    v_pk_fma_f32 v[82:83], v[88:89], v[80:81], v[90:91] op_sel:[1,1,0] op_sel_hi:[0,1,1] neg_lo:[1,0,0]
    v_cvt_pk_bf16_f32 v190, v82, v83
    ds_write2st64_b32 v124, v182, v190 offset0:152 offset1:184
    buffer_load_dwordx4 v19, s[36:39], s1 offen offset:3072 lds
    global_load_dword v2, v12, s[32:33] sc1
    s_waitcnt vmcnt(10) lgkmcnt(0)
    s_barrier
    ds_read_b128 v[104:107], v24 offset:0
    ds_read_b64_tr_b16 v[96:97], v28 offset:16384
    ds_read_b64_tr_b16 v[98:99], v28 offset:17408
    ds_read_b128 v[108:111], v25 offset:4096
    ds_read_b64_tr_b16 v[100:101], v29 offset:16384
    ds_read_b64_tr_b16 v[102:103], v29 offset:17408
    ds_read2_b32 v[238:239], v232 offset0:0 offset1:32
    ds_read2_b32 v[240:241], v233 offset0:64 offset1:96
    ds_read2_b32 v[242:243], v234 offset0:128 offset1:160
    ds_read2_b32 v[244:245], v235 offset0:192 offset1:224
    s_waitcnt lgkmcnt(4)
    v_mfma_f32_32x32x16_bf16 v[32:47], v[96:99], v[104:107], 0
    ds_read_b128 v[120:123], v25 offset:0
    ds_read_b64_tr_b16 v[112:113], v28 offset:20480
    ds_read_b64_tr_b16 v[114:115], v28 offset:21504
    s_xor_b32 s0, s19, 2
    v_mfma_f32_32x32x16_bf16 v[48:63], v[100:103], v[104:107], 0
    ds_read_b128 v[124:127], v24 offset:4096
    ds_read_b64_tr_b16 v[116:117], v29 offset:20480
    ds_read_b64_tr_b16 v[118:119], v29 offset:21504
    s_add_u32 m0, s73, 114688
    s_mul_i32 s0, s0, 229376
    s_add_u32 s0, s89, s0
    v_mfma_f32_32x32x16_bf16 v[80:95], v[100:103], v[108:111], 0
    buffer_load_dwordx4 v20, s[40:43], s0 offen offset:0 lds
    s_waitcnt lgkmcnt(6)
    v_perm_b32 v246, v239, v238, s10
    v_mfma_f32_32x32x16_bf16 v[64:79], v[96:99], v[108:111], 0
    buffer_load_dwordx4 v21, s[40:43], s0 offen offset:1024 lds
    s_xor_b32 s1, s1, 384
    s_waitcnt lgkmcnt(0)
    v_mfma_f32_32x32x16_bf16 v[32:47], v[112:115], v[120:123], v[32:47]
    ds_read_b128 v[104:107], v26 offset:0
    ds_read_b64_tr_b16 v[96:97], v28 offset:24576
    ds_read_b64_tr_b16 v[98:99], v28 offset:25600
    ds_read_b128 v[144:147], v208 offset:48128
    v_mfma_f32_32x32x16_bf16 v[48:63], v[116:119], v[120:123], v[48:63]
    ds_read_b128 v[108:111], v27 offset:4096
    ds_read_b64_tr_b16 v[100:101], v29 offset:24576
    ds_read_b64_tr_b16 v[102:103], v29 offset:25600
    ds_read_b128 v[148:151], v212 offset:0
    v_mfma_f32_32x32x16_bf16 v[80:95], v[116:119], v[124:127], v[80:95]
    ds_read_b128 v[152:155], v216 offset:0
    ds_read_b128 v[156:159], v220 offset:0
    buffer_load_dwordx4 v22, s[40:43], s0 offen offset:2048 lds
    v_mfma_f32_32x32x16_bf16 v[64:79], v[112:115], v[124:127], v[64:79]
    ds_read_b128 v[160:163], v224 offset:0
    buffer_load_dwordx4 v23, s[40:43], s0 offen offset:3072 lds
    s_add_u32 m0, s73, 32768
    s_waitcnt lgkmcnt(4)
    v_mfma_f32_32x32x16_bf16 v[32:47], v[96:99], v[104:107], v[32:47]
    ds_read_b128 v[120:123], v27 offset:0
    ds_read_b64_tr_b16 v[112:113], v28 offset:28672
    ds_read_b64_tr_b16 v[114:115], v28 offset:29696
    ds_read_b128 v[164:167], v209 offset:48128
    v_mfma_f32_32x32x16_bf16 v[48:63], v[100:103], v[104:107], v[48:63]
    ds_read_b128 v[124:127], v26 offset:4096
    ds_read_b64_tr_b16 v[116:117], v29 offset:28672
    ds_read_b64_tr_b16 v[118:119], v29 offset:29696
    ds_read_b128 v[168:171], v213 offset:0
    v_mfma_f32_32x32x16_bf16 v[80:95], v[100:103], v[108:111], v[80:95]
    ds_read_b128 v[172:175], v217 offset:0
    ds_read_b128 v[176:179], v221 offset:0
    buffer_load_dwordx4 v16, s[36:39], s1 offen offset:0 lds
    v_mfma_f32_32x32x16_bf16 v[64:79], v[96:99], v[108:111], v[64:79]
    ds_read_b128 v[180:183], v225 offset:0
    buffer_load_dwordx4 v17, s[36:39], s1 offen offset:1024 lds
    s_xor_b32 s0, s19, 3
    s_waitcnt lgkmcnt(11)
    v_mfma_f32_16x16x32_bf16 v[128:131], v[148:151], v[144:147], v[128:131]
    ds_read_b128 v[184:187], v210 offset:48128
    s_mul_i32 s0, s0, 229376
    s_add_u32 s0, s89, s0
    v_perm_b32 v247, v241, v240, s10
    v_mfma_f32_16x16x32_bf16 v[132:135], v[152:155], v[144:147], 0
    ds_read_b128 v[188:191], v214 offset:0
    buffer_load_dwordx4 v18, s[36:39], s1 offen offset:2048 lds
    v_mfma_f32_16x16x32_bf16 v[136:139], v[156:159], v[144:147], 0
    ds_read_b128 v[192:195], v218 offset:0
    v_perm_b32 v248, v243, v242, s10
    v_perm_b32 v249, v245, v244, s10
    v_perm_b32 v250, v239, v238, s11
    v_mfma_f32_16x16x32_bf16 v[140:143], v[160:163], v[144:147], 0
    ds_read_b128 v[196:199], v222 offset:0
    ds_read_b128 v[200:203], v226 offset:0
    s_waitcnt lgkmcnt(5)
    v_mfma_f32_16x16x32_bf16 v[128:131], v[168:171], v[164:167], v[128:131]
    ds_read_b128 v[144:147], v211 offset:48128
    buffer_load_dwordx4 v19, s[36:39], s1 offen offset:3072 lds
    v_mfma_f32_16x16x32_bf16 v[132:135], v[172:175], v[164:167], v[132:135]
    ds_read_b128 v[148:151], v215 offset:0
    v_perm_b32 v251, v241, v240, s11
    v_perm_b32 v252, v243, v242, s11
    v_perm_b32 v253, v245, v244, s11
    v_mfma_f32_16x16x32_bf16 v[136:139], v[176:179], v[164:167], v[136:139]
    ds_read_b128 v[152:155], v219 offset:0
    v_mov_b32 v228, -1
    v_mov_b32 v229, -1
    v_mov_b32 v230, -1
    v_mfma_f32_16x16x32_bf16 v[140:143], v[180:183], v[164:167], v[140:143]
    ds_read_b128 v[156:159], v223 offset:0
    ds_read_b128 v[160:163], v227 offset:0
    s_add_u32 m0, s73, 131072
    s_waitcnt vmcnt(9)
    s_barrier
    v_mfma_f32_32x32x16_bf16 v[32:47], v[112:115], v[120:123], v[32:47]
    ds_read_b128 v[104:107], v24 offset:16384
    ds_read_b64_tr_b16 v[96:97], v28 offset:32768
    ds_read_b64_tr_b16 v[98:99], v28 offset:33792
    v_mov_b32_e64 v231, -1
    v_mfma_f32_32x32x16_bf16 v[48:63], v[116:119], v[120:123], v[48:63]
    ds_read_b128 v[108:111], v25 offset:20480
    ds_read_b64_tr_b16 v[100:101], v29 offset:32768
    ds_read_b64_tr_b16 v[102:103], v29 offset:33792
    s_mul_i32 s84, s56, 4224
    v_mfma_f32_32x32x16_bf16 v[80:95], v[116:119], v[124:127], v[80:95]
    buffer_load_dwordx4 v20, s[40:43], s0 offen offset:0 lds
    s_add_u32 s84, s84, 49280
    s_mul_i32 s61, s56, 4640
    v_mfma_f32_32x32x16_bf16 v[64:79], v[112:115], v[124:127], v[64:79]
    buffer_load_dwordx4 v21, s[40:43], s0 offen offset:1024 lds
    s_xor_b32 s1, s1, 128
    s_waitcnt lgkmcnt(0)
    v_mfma_f32_32x32x16_bf16 v[32:47], v[96:99], v[104:107], v[32:47]
    ds_read_b128 v[120:123], v25 offset:16384
    ds_read_b64_tr_b16 v[112:113], v28 offset:36864
    ds_read_b64_tr_b16 v[114:115], v28 offset:37888
    s_add_u32 s61, s61, 70400
    v_mfma_f32_32x32x16_bf16 v[48:63], v[100:103], v[104:107], v[48:63]
    ds_read_b128 v[124:127], v24 offset:20480
    ds_read_b64_tr_b16 v[116:117], v29 offset:36864
    ds_read_b64_tr_b16 v[118:119], v29 offset:37888
    v_lshl_add_u32 v205, v0, 2, s61
    v_mfma_f32_32x32x16_bf16 v[80:95], v[100:103], v[108:111], v[80:95]
    buffer_load_dwordx4 v22, s[40:43], s0 offen offset:2048 lds
    s_sub_u32 s61, s84, 128
    v_and_b32 v206, 31, v0
    v_mfma_f32_32x32x16_bf16 v[64:79], v[96:99], v[108:111], v[64:79]
    buffer_load_dwordx4 v23, s[40:43], s0 offen offset:3072 lds
    s_add_u32 m0, s73, 0
    s_waitcnt lgkmcnt(0)
    v_mfma_f32_32x32x16_bf16 v[32:47], v[112:115], v[120:123], v[32:47]
    ds_read_b128 v[104:107], v26 offset:16384
    ds_read_b64_tr_b16 v[96:97], v28 offset:40960
    ds_read_b64_tr_b16 v[98:99], v28 offset:41984
    v_lshl_add_u32 v206, v206, 2, s61
    v_mfma_f32_32x32x16_bf16 v[48:63], v[116:119], v[120:123], v[48:63]
    ds_read_b128 v[108:111], v27 offset:20480
    ds_read_b64_tr_b16 v[100:101], v29 offset:40960
    ds_read_b64_tr_b16 v[102:103], v29 offset:41984
    s_mul_i32 s61, s87, 9280
    v_mfma_f32_32x32x16_bf16 v[80:95], v[116:119], v[124:127], v[80:95]
    buffer_load_dwordx4 v16, s[36:39], s1 offen offset:0 lds
    s_lshl_b32 s63, s95, 11
    s_sub_u32 s61, s61, s63
    v_mfma_f32_32x32x16_bf16 v[64:79], v[112:115], v[124:127], v[64:79]
    buffer_load_dwordx4 v17, s[36:39], s1 offen offset:1024 lds
    s_add_u32 s61, s61, 70368
    s_waitcnt lgkmcnt(0)
    v_mfma_f32_32x32x16_bf16 v[32:47], v[96:99], v[104:107], v[32:47]
    ds_read_b128 v[120:123], v27 offset:16384
    ds_read_b64_tr_b16 v[112:113], v28 offset:45056
    ds_read_b64_tr_b16 v[114:115], v28 offset:46080
    v_lshlrev_b32 v204, 5, v0
    v_mfma_f32_32x32x16_bf16 v[48:63], v[100:103], v[104:107], v[48:63]
    ds_read_b128 v[124:127], v26 offset:20480
    ds_read_b64_tr_b16 v[116:117], v29 offset:45056
    ds_read_b64_tr_b16 v[118:119], v29 offset:46080
    v_sub_u32_e64 v204, s61, v204
    v_mfma_f32_32x32x16_bf16 v[80:95], v[100:103], v[108:111], v[80:95]
    buffer_load_dwordx4 v18, s[36:39], s1 offen offset:2048 lds
    s_lshr_b32 s61, s74, 2
    s_add_u32 s61, s61, 14712832
    v_mfma_f32_32x32x16_bf16 v[64:79], v[96:99], v[108:111], v[64:79]
    buffer_load_dwordx4 v19, s[36:39], s1 offen offset:3072 lds
    v_and_b32 v31, 31, v0
    v_mfma_f32_16x16x32_bf16 v[128:131], v[188:191], v[184:187], v[128:131]
    ds_read_b128 v[164:167], v208 offset:48384
    v_lshlrev_b32 v31, 4, v31
    v_lshrrev_b32 v3, 5, v0
    v_lshl_add_u32 v30, v3, 31, v31
    v_mfma_f32_16x16x32_bf16 v[132:135], v[192:195], v[184:187], v[132:135]
    ds_read_b128 v[168:171], v212 offset:256
    buffer_store_dwordx4 v[246:249], v236, s[48:51], s6 offen sc1
    v_mfma_f32_16x16x32_bf16 v[136:139], v[196:199], v[184:187], v[136:139]
    ds_read_b128 v[172:175], v216 offset:256
    v_add_u32 v30, s61, v30
    v_ashrrev_i32 v3, 31, v30
    s_lshl1_add_u32 s92, s83, s57
    v_mfma_f32_16x16x32_bf16 v[140:143], v[200:203], v[184:187], v[140:143]
    ds_read_b128 v[176:179], v220 offset:256
    ds_read_b128 v[180:183], v224 offset:256
    v_mfma_f32_16x16x32_bf16 v[128:131], v[148:151], v[144:147], v[128:131]
    ds_read_b128 v[184:187], v209 offset:48384
    buffer_store_dwordx4 v[250:253], v236, s[48:51], s7 offen sc1
    v_mfma_f32_16x16x32_bf16 v[132:135], v[152:155], v[144:147], v[132:135]
    ds_read_b128 v[188:191], v213 offset:256
    s_lshl_b32 s92, s92, 9
    s_add_u32 s92, s92, 14680064
    s_xor_b32 s90, s92, 512
    v_mfma_f32_16x16x32_bf16 v[136:139], v[156:159], v[144:147], v[136:139]
    ds_read_b128 v[192:195], v217 offset:256
    s_lshl_b32 s62, s83, 13
    s_lshr_b32 s61, s74, 4
    s_add_u32 s18, s61, s62
    v_mfma_f32_16x16x32_bf16 v[140:143], v[160:163], v[144:147], v[140:143]
    ds_read_b128 v[196:199], v221 offset:256
    ds_read_b128 v[200:203], v225 offset:256
    buffer_store_dwordx4 v[228:231], v1, s[48:51], s81 offen offset:0 sc1
    s_waitcnt lgkmcnt(5)
    v_mfma_f32_16x16x32_bf16 v[128:131], v[168:171], v[164:167], v[128:131]
    ds_read_b128 v[144:147], v210 offset:48384
    s_xor_b32 s0, s19, 4
    s_mul_i32 s0, s0, 229376
    s_add_u32 s0, s89, s0
    v_mfma_f32_16x16x32_bf16 v[132:135], v[172:175], v[164:167], v[132:135]
    ds_read_b128 v[148:151], v214 offset:256
    s_add_u32 s18, s18, 14942208
    s_add_u32 s91, s85, s74
    v_mfma_f32_16x16x32_bf16 v[136:139], v[176:179], v[164:167], v[136:139]
    ds_read_b128 v[152:155], v218 offset:256
    buffer_store_dwordx4 v[228:231], v1, s[48:51], s81 offen offset:1024 sc1
    v_mfma_f32_16x16x32_bf16 v[140:143], v[180:183], v[164:167], v[140:143]
    ds_read_b128 v[156:159], v222 offset:256
    ds_read_b128 v[160:163], v226 offset:256
    s_waitcnt lgkmcnt(5)
    v_mfma_f32_16x16x32_bf16 v[128:131], v[188:191], v[184:187], v[128:131]
    ds_read_b128 v[164:167], v211 offset:48384
    v_mfma_f32_16x16x32_bf16 v[132:135], v[192:195], v[184:187], v[132:135]
    ds_read_b128 v[168:171], v215 offset:256
    v_mfma_f32_16x16x32_bf16 v[136:139], v[196:199], v[184:187], v[136:139]
    ds_read_b128 v[172:175], v219 offset:256
    v_mfma_f32_16x16x32_bf16 v[140:143], v[200:203], v[184:187], v[140:143]
    ds_read_b128 v[176:179], v223 offset:256
    ds_read_b128 v[180:183], v227 offset:256
    s_waitcnt lgkmcnt(5)
    v_mfma_f32_16x16x32_bf16 v[128:131], v[148:151], v[144:147], v[128:131]
    v_mfma_f32_16x16x32_bf16 v[132:135], v[152:155], v[144:147], v[132:135]
    v_mfma_f32_16x16x32_bf16 v[136:139], v[156:159], v[144:147], v[136:139]
    v_mfma_f32_16x16x32_bf16 v[140:143], v[160:163], v[144:147], v[140:143]
    s_waitcnt lgkmcnt(0)
    s_barrier
    v_mfma_f32_16x16x32_bf16 v[128:131], v[168:171], v[164:167], v[128:131]
    v_mfma_f32_16x16x32_bf16 v[132:135], v[172:175], v[164:167], v[132:135]
    v_mfma_f32_16x16x32_bf16 v[136:139], v[176:179], v[164:167], v[136:139]
    s_add_u32 m0, s73, 147456
    v_mfma_f32_16x16x32_bf16 v[140:143], v[180:183], v[164:167], v[140:143]
    ds_write2st64_b32 v205, v12, v12 offset1:1
    ds_write_b32 v206, v12
    s_nop 1
    v_cvt_pk_bf16_f32 v144, v128, v129
    v_cvt_pk_bf16_f32 v145, v130, v131
    v_cvt_pk_bf16_f32 v146, v132, v133
    v_cvt_pk_bf16_f32 v147, v134, v135
    v_cvt_pk_bf16_f32 v148, v136, v137
    v_cvt_pk_bf16_f32 v149, v138, v139
    v_cvt_pk_bf16_f32 v150, v140, v141
    v_cvt_pk_bf16_f32 v151, v142, v143
    v_permlane32_swap_b32 v144, v148
    v_permlane32_swap_b32 v146, v150
    v_permlane32_swap_b32 v145, v149
    v_permlane32_swap_b32 v147, v151
    v_permlane16_swap_b32 v144, v146
    v_permlane16_swap_b32 v148, v150
    v_permlane16_swap_b32 v145, v147
    v_permlane16_swap_b32 v149, v151
    ds_write_b128 v204, v[144:147] offset:0
    s_lshl_b32 s94, s95, 4
    v_bfe_u32 v152, v151, 16, s94
    v_alignbit_b32 v154, v145, v144, 16
    v_alignbit_b32 v155, v146, v145, 16
    v_alignbit_b32 v156, v147, v146, 16
    v_alignbit_b32 v157, v148, v147, 16
    ds_write_b128 v204, v[148:151] offset:16
    v_alignbit_b32 v158, v149, v148, 16
    v_alignbit_b32 v159, v150, v149, 16
    v_alignbit_b32 v160, v151, v150, 16
    v_mov_b32_dpp v152, v144 wave_shr:1 row_mask:0xf bank_mask:0xf
    v_alignbit_b32 v161, v152, v151, 16
    ds_write_b128 v204, v[154:157] offset:4640
    ds_write_b128 v204, v[158:161] offset:4656
    s_waitcnt vmcnt(12)
    s_barrier
    v_mfma_f32_32x32x16_bf16 v[32:47], v[112:115], v[120:123], v[32:47]
    ds_read_b128 v[104:107], v24 offset:32768
    ds_read_b64_tr_b16 v[96:97], v28 offset:0
    ds_read_b64_tr_b16 v[98:99], v28 offset:1024
    v_mfma_f32_32x32x16_bf16 v[48:63], v[116:119], v[120:123], v[48:63]
    ds_read_b128 v[108:111], v25 offset:36864
    ds_read_b64_tr_b16 v[100:101], v29 offset:0
    ds_read_b64_tr_b16 v[102:103], v29 offset:1024
    v_and_b32 v218, 31, v0
    v_mfma_f32_32x32x16_bf16 v[80:95], v[116:119], v[124:127], v[80:95]
    buffer_load_dwordx4 v20, s[40:43], s0 offen offset:0 lds
    v_cmp_eq_u32 vcc, 0, v2
    s_cbranch_vccnz SLOW_NON
BACK_NON:
    v_mfma_f32_32x32x16_bf16 v[64:79], v[112:115], v[124:127], v[64:79]
    buffer_load_dwordx4 v21, s[40:43], s0 offen offset:1024 lds
    s_xor_b32 s1, s1, 896
    s_waitcnt lgkmcnt(0)
    v_mfma_f32_32x32x16_bf16 v[32:47], v[96:99], v[104:107], v[32:47]
    ds_read_b128 v[120:123], v25 offset:32768
    ds_read_b64_tr_b16 v[112:113], v28 offset:4096
    ds_read_b64_tr_b16 v[114:115], v28 offset:5120
    v_lshlrev_b32 v218, 2, v218
    v_mfma_f32_32x32x16_bf16 v[48:63], v[100:103], v[104:107], v[48:63]
    ds_read_b128 v[124:127], v24 offset:36864
    ds_read_b64_tr_b16 v[116:117], v29 offset:4096
    ds_read_b64_tr_b16 v[118:119], v29 offset:5120
    v_lshl_add_u32 v217, s82, 7, v218
    v_mfma_f32_32x32x16_bf16 v[80:95], v[100:103], v[108:111], v[80:95]
    buffer_load_dwordx4 v22, s[40:43], s0 offen offset:2048 lds
    v_add_u32 v218, 90112, v218
    v_mfma_f32_32x32x16_bf16 v[64:79], v[96:99], v[108:111], v[64:79]
    buffer_load_dwordx4 v23, s[40:43], s0 offen offset:3072 lds
    s_add_u32 m0, s73, 16384
    s_waitcnt lgkmcnt(0)
    v_mfma_f32_32x32x16_bf16 v[32:47], v[112:115], v[120:123], v[32:47]
    ds_read_b128 v[104:107], v26 offset:32768
    ds_read_b64_tr_b16 v[96:97], v28 offset:8192
    ds_read_b64_tr_b16 v[98:99], v28 offset:9216
    v_mfma_f32_32x32x16_bf16 v[48:63], v[116:119], v[120:123], v[48:63]
    ds_read_b128 v[108:111], v27 offset:36864
    ds_read_b64_tr_b16 v[100:101], v29 offset:8192
    ds_read_b64_tr_b16 v[102:103], v29 offset:9216
    v_mfma_f32_32x32x16_bf16 v[80:95], v[116:119], v[124:127], v[80:95]
    buffer_load_dwordx4 v16, s[36:39], s1 offen offset:0 lds
    v_mfma_f32_32x32x16_bf16 v[64:79], v[112:115], v[124:127], v[64:79]
    buffer_load_dwordx4 v17, s[36:39], s1 offen offset:1024 lds
    s_xor_b32 s0, s19, 5
    s_waitcnt lgkmcnt(0)
    v_mfma_f32_32x32x16_bf16 v[32:47], v[96:99], v[104:107], v[32:47]
    ds_read_b128 v[120:123], v27 offset:32768
    ds_read_b64_tr_b16 v[112:113], v28 offset:12288
    ds_read_b64_tr_b16 v[114:115], v28 offset:13312
    s_mul_i32 s0, s0, 229376
    v_mfma_f32_32x32x16_bf16 v[48:63], v[100:103], v[104:107], v[48:63]
    ds_read_b128 v[124:127], v26 offset:36864
    ds_read_b64_tr_b16 v[116:117], v29 offset:12288
    ds_read_b64_tr_b16 v[118:119], v29 offset:13312
    s_add_u32 s0, s89, s0
    v_mfma_f32_32x32x16_bf16 v[80:95], v[100:103], v[108:111], v[80:95]
    buffer_load_dwordx4 v18, s[36:39], s1 offen offset:2048 lds
    v_mfma_f32_32x32x16_bf16 v[64:79], v[96:99], v[108:111], v[64:79]
    buffer_load_dwordx4 v19, s[36:39], s1 offen offset:3072 lds
    s_add_u32 m0, s73, 114688
    s_waitcnt vmcnt(12) lgkmcnt(0)
    s_barrier
    v_mfma_f32_32x32x16_bf16 v[32:47], v[112:115], v[120:123], v[32:47]
    ds_read_b128 v[104:107], v24 offset:0
    ds_read_b64_tr_b16 v[96:97], v28 offset:16384
    ds_read_b64_tr_b16 v[98:99], v28 offset:17408
    v_mfma_f32_32x32x16_bf16 v[48:63], v[116:119], v[120:123], v[48:63]
    ds_read_b128 v[108:111], v25 offset:4096
    ds_read_b64_tr_b16 v[100:101], v29 offset:16384
    ds_read_b64_tr_b16 v[102:103], v29 offset:17408
    v_mfma_f32_32x32x16_bf16 v[80:95], v[116:119], v[124:127], v[80:95]
    buffer_load_dwordx4 v20, s[40:43], s0 offen offset:0 lds
    v_mfma_f32_32x32x16_bf16 v[64:79], v[112:115], v[124:127], v[64:79]
    buffer_load_dwordx4 v21, s[40:43], s0 offen offset:1024 lds
    s_xor_b32 s1, s1, 128
    s_waitcnt lgkmcnt(0)
    v_mfma_f32_32x32x16_bf16 v[32:47], v[96:99], v[104:107], v[32:47]
    ds_read_b128 v[120:123], v25 offset:0
    ds_read_b64_tr_b16 v[112:113], v28 offset:20480
    ds_read_b64_tr_b16 v[114:115], v28 offset:21504
    v_mfma_f32_32x32x16_bf16 v[48:63], v[100:103], v[104:107], v[48:63]
    ds_read_b128 v[124:127], v24 offset:4096
    ds_read_b64_tr_b16 v[116:117], v29 offset:20480
    ds_read_b64_tr_b16 v[118:119], v29 offset:21504
    v_mfma_f32_32x32x16_bf16 v[80:95], v[100:103], v[108:111], v[80:95]
    buffer_load_dwordx4 v22, s[40:43], s0 offen offset:2048 lds
    v_mfma_f32_32x32x16_bf16 v[64:79], v[96:99], v[108:111], v[64:79]
    buffer_load_dwordx4 v23, s[40:43], s0 offen offset:3072 lds
    s_add_u32 m0, s73, 32768
    s_waitcnt lgkmcnt(0)
    v_mfma_f32_32x32x16_bf16 v[32:47], v[112:115], v[120:123], v[32:47]
    ds_read_b128 v[104:107], v26 offset:0
    ds_read_b64_tr_b16 v[96:97], v28 offset:24576
    ds_read_b64_tr_b16 v[98:99], v28 offset:25600
    v_mfma_f32_32x32x16_bf16 v[48:63], v[116:119], v[120:123], v[48:63]
    ds_read_b128 v[108:111], v27 offset:4096
    ds_read_b64_tr_b16 v[100:101], v29 offset:24576
    ds_read_b64_tr_b16 v[102:103], v29 offset:25600
    v_mfma_f32_32x32x16_bf16 v[80:95], v[116:119], v[124:127], v[80:95]
    buffer_load_dwordx4 v16, s[36:39], s1 offen offset:0 lds
    v_mfma_f32_32x32x16_bf16 v[64:79], v[112:115], v[124:127], v[64:79]
    buffer_load_dwordx4 v17, s[36:39], s1 offen offset:1024 lds
    s_xor_b32 s0, s19, 6
    s_waitcnt lgkmcnt(0)
    v_mfma_f32_32x32x16_bf16 v[32:47], v[96:99], v[104:107], v[32:47]
    ds_read_b128 v[120:123], v27 offset:0
    ds_read_b64_tr_b16 v[112:113], v28 offset:28672
    ds_read_b64_tr_b16 v[114:115], v28 offset:29696
    s_mul_i32 s0, s0, 229376
    v_mfma_f32_32x32x16_bf16 v[48:63], v[100:103], v[104:107], v[48:63]
    ds_read_b128 v[124:127], v26 offset:4096
    ds_read_b64_tr_b16 v[116:117], v29 offset:28672
    ds_read_b64_tr_b16 v[118:119], v29 offset:29696
    s_add_u32 s0, s89, s0
    v_mfma_f32_32x32x16_bf16 v[80:95], v[100:103], v[108:111], v[80:95]
    buffer_load_dwordx4 v18, s[36:39], s1 offen offset:2048 lds
    v_mfma_f32_32x32x16_bf16 v[64:79], v[96:99], v[108:111], v[64:79]
    buffer_load_dwordx4 v19, s[36:39], s1 offen offset:3072 lds
    s_add_u32 m0, s73, 131072
    s_waitcnt vmcnt(8) lgkmcnt(0)
    s_barrier
    v_mfma_f32_32x32x16_bf16 v[32:47], v[112:115], v[120:123], v[32:47]
    ds_read_b128 v[104:107], v24 offset:16384
    ds_read_b64_tr_b16 v[96:97], v28 offset:32768
    ds_read_b64_tr_b16 v[98:99], v28 offset:33792
    v_mfma_f32_32x32x16_bf16 v[48:63], v[116:119], v[120:123], v[48:63]
    ds_read_b128 v[108:111], v25 offset:20480
    ds_read_b64_tr_b16 v[100:101], v29 offset:32768
    ds_read_b64_tr_b16 v[102:103], v29 offset:33792
    v_mfma_f32_32x32x16_bf16 v[80:95], v[116:119], v[124:127], v[80:95]
    buffer_load_dwordx4 v20, s[40:43], s0 offen offset:0 lds
    v_mfma_f32_32x32x16_bf16 v[64:79], v[112:115], v[124:127], v[64:79]
    buffer_load_dwordx4 v21, s[40:43], s0 offen offset:1024 lds
    s_xor_b32 s1, s1, 384
    s_waitcnt lgkmcnt(0)
    v_mfma_f32_32x32x16_bf16 v[32:47], v[96:99], v[104:107], v[32:47]
    ds_read_b128 v[120:123], v25 offset:16384
    ds_read_b64_tr_b16 v[112:113], v28 offset:36864
    ds_read_b64_tr_b16 v[114:115], v28 offset:37888
    v_mfma_f32_32x32x16_bf16 v[48:63], v[100:103], v[104:107], v[48:63]
    ds_read_b128 v[124:127], v24 offset:20480
    ds_read_b64_tr_b16 v[116:117], v29 offset:36864
    ds_read_b64_tr_b16 v[118:119], v29 offset:37888
    v_mfma_f32_32x32x16_bf16 v[80:95], v[100:103], v[108:111], v[80:95]
    buffer_load_dwordx4 v22, s[40:43], s0 offen offset:2048 lds
    v_mfma_f32_32x32x16_bf16 v[64:79], v[96:99], v[108:111], v[64:79]
    buffer_load_dwordx4 v23, s[40:43], s0 offen offset:3072 lds
    s_add_u32 m0, s73, 0
    s_waitcnt lgkmcnt(0)
    v_mfma_f32_32x32x16_bf16 v[32:47], v[112:115], v[120:123], v[32:47]
    ds_read_b128 v[104:107], v26 offset:16384
    ds_read_b64_tr_b16 v[96:97], v28 offset:40960
    ds_read_b64_tr_b16 v[98:99], v28 offset:41984
    v_mfma_f32_32x32x16_bf16 v[48:63], v[116:119], v[120:123], v[48:63]
    ds_read_b128 v[108:111], v27 offset:20480
    ds_read_b64_tr_b16 v[100:101], v29 offset:40960
    ds_read_b64_tr_b16 v[102:103], v29 offset:41984
    v_mfma_f32_32x32x16_bf16 v[80:95], v[116:119], v[124:127], v[80:95]
    buffer_load_dwordx4 v16, s[36:39], s1 offen offset:0 lds
    v_mfma_f32_32x32x16_bf16 v[64:79], v[112:115], v[124:127], v[64:79]
    buffer_load_dwordx4 v17, s[36:39], s1 offen offset:1024 lds
    s_xor_b32 s0, s19, 7
    s_waitcnt lgkmcnt(0)
    v_mfma_f32_32x32x16_bf16 v[32:47], v[96:99], v[104:107], v[32:47]
    ds_read_b128 v[120:123], v27 offset:16384
    ds_read_b64_tr_b16 v[112:113], v28 offset:45056
    ds_read_b64_tr_b16 v[114:115], v28 offset:46080
    s_mul_i32 s0, s0, 229376
    v_mfma_f32_32x32x16_bf16 v[48:63], v[100:103], v[104:107], v[48:63]
    ds_read_b128 v[124:127], v26 offset:20480
    ds_read_b64_tr_b16 v[116:117], v29 offset:45056
    ds_read_b64_tr_b16 v[118:119], v29 offset:46080
    s_add_u32 s0, s89, s0
    v_mfma_f32_32x32x16_bf16 v[80:95], v[100:103], v[108:111], v[80:95]
    buffer_load_dwordx4 v18, s[36:39], s1 offen offset:2048 lds
    v_mfma_f32_32x32x16_bf16 v[64:79], v[96:99], v[108:111], v[64:79]
    buffer_load_dwordx4 v19, s[36:39], s1 offen offset:3072 lds
    s_add_u32 m0, s73, 147456
    s_waitcnt vmcnt(8) lgkmcnt(0)
    s_barrier
    v_mfma_f32_32x32x16_bf16 v[32:47], v[112:115], v[120:123], v[32:47]
    ds_read_b128 v[104:107], v24 offset:32768
    ds_read_b64_tr_b16 v[96:97], v28 offset:0
    ds_read_b64_tr_b16 v[98:99], v28 offset:1024
    v_mfma_f32_32x32x16_bf16 v[48:63], v[116:119], v[120:123], v[48:63]
    ds_read_b128 v[108:111], v25 offset:36864
    ds_read_b64_tr_b16 v[100:101], v29 offset:0
    ds_read_b64_tr_b16 v[102:103], v29 offset:1024
    v_mfma_f32_32x32x16_bf16 v[80:95], v[116:119], v[124:127], v[80:95]
    buffer_load_dwordx4 v20, s[40:43], s0 offen offset:0 lds
    v_mfma_f32_32x32x16_bf16 v[64:79], v[112:115], v[124:127], v[64:79]
    buffer_load_dwordx4 v21, s[40:43], s0 offen offset:1024 lds
    s_xor_b32 s1, s1, 128
    s_waitcnt lgkmcnt(0)
    v_mfma_f32_32x32x16_bf16 v[32:47], v[96:99], v[104:107], v[32:47]
    ds_read_b128 v[120:123], v25 offset:32768
    ds_read_b64_tr_b16 v[112:113], v28 offset:4096
    ds_read_b64_tr_b16 v[114:115], v28 offset:5120
    v_mfma_f32_32x32x16_bf16 v[48:63], v[100:103], v[104:107], v[48:63]
    ds_read_b128 v[124:127], v24 offset:36864
    ds_read_b64_tr_b16 v[116:117], v29 offset:4096
    ds_read_b64_tr_b16 v[118:119], v29 offset:5120
    v_mfma_f32_32x32x16_bf16 v[80:95], v[100:103], v[108:111], v[80:95]
    buffer_load_dwordx4 v22, s[40:43], s0 offen offset:2048 lds
    v_mfma_f32_32x32x16_bf16 v[64:79], v[96:99], v[108:111], v[64:79]
    buffer_load_dwordx4 v23, s[40:43], s0 offen offset:3072 lds
    s_add_u32 m0, s73, 16384
    s_waitcnt lgkmcnt(0)
    v_mfma_f32_32x32x16_bf16 v[32:47], v[112:115], v[120:123], v[32:47]
    ds_read_b128 v[104:107], v26 offset:32768
    ds_read_b64_tr_b16 v[96:97], v28 offset:8192
    ds_read_b64_tr_b16 v[98:99], v28 offset:9216
    v_mfma_f32_32x32x16_bf16 v[48:63], v[116:119], v[120:123], v[48:63]
    ds_read_b128 v[108:111], v27 offset:36864
    ds_read_b64_tr_b16 v[100:101], v29 offset:8192
    ds_read_b64_tr_b16 v[102:103], v29 offset:9216
    v_mfma_f32_32x32x16_bf16 v[80:95], v[116:119], v[124:127], v[80:95]
    buffer_load_dwordx4 v16, s[36:39], s1 offen offset:0 lds
    v_mfma_f32_32x32x16_bf16 v[64:79], v[112:115], v[124:127], v[64:79]
    buffer_load_dwordx4 v17, s[36:39], s1 offen offset:1024 lds
    s_waitcnt lgkmcnt(0)
    v_mfma_f32_32x32x16_bf16 v[32:47], v[96:99], v[104:107], v[32:47]
    ds_read_b128 v[120:123], v27 offset:32768
    ds_read_b64_tr_b16 v[112:113], v28 offset:12288
    ds_read_b64_tr_b16 v[114:115], v28 offset:13312
    v_mfma_f32_32x32x16_bf16 v[48:63], v[100:103], v[104:107], v[48:63]
    ds_read_b128 v[124:127], v26 offset:36864
    ds_read_b64_tr_b16 v[116:117], v29 offset:12288
    ds_read_b64_tr_b16 v[118:119], v29 offset:13312
    v_mfma_f32_32x32x16_bf16 v[80:95], v[100:103], v[108:111], v[80:95]
    buffer_load_dwordx4 v18, s[36:39], s1 offen offset:2048 lds
    v_mfma_f32_32x32x16_bf16 v[64:79], v[96:99], v[108:111], v[64:79]
    buffer_load_dwordx4 v19, s[36:39], s1 offen offset:3072 lds
    s_add_u32 m0, s73, 98304
    s_lshl4_add_u32 s3, s74, s72
    s_waitcnt vmcnt(8) lgkmcnt(0)
    s_barrier
    v_mfma_f32_32x32x16_bf16 v[32:47], v[112:115], v[120:123], v[32:47]
    ds_read_b128 v[104:107], v24 offset:0
    ds_read_b64_tr_b16 v[96:97], v28 offset:16384
    ds_read_b64_tr_b16 v[98:99], v28 offset:17408
    global_load_dword v217, v217, s[26:27]
    v_mfma_f32_32x32x16_bf16 v[48:63], v[116:119], v[120:123], v[48:63]
    ds_read_b128 v[108:111], v25 offset:4096
    ds_read_b64_tr_b16 v[100:101], v29 offset:16384
    ds_read_b64_tr_b16 v[102:103], v29 offset:17408
    s_mov_b64 exec, 0xff
    buffer_store_dwordx4 v[2:5], v1, s[48:51], s8 offen offset:0 sc1
    s_mov_b64 exec, -1
    v_mfma_f32_32x32x16_bf16 v[80:95], v[116:119], v[124:127], v[80:95]
    buffer_load_dwordx4 v4, s[44:47], s3 offen offset:0 lds
    v_lshrrev_b32_e64 v19, 4, v0
    v_bfe_u32 v20, v0, 1, 3
    v_mfma_f32_32x32x16_bf16 v[64:79], v[112:115], v[124:127], v[64:79]
IW1:
    s_cbranch_execz IWBACK
    s_nop 0
    buffer_load_dwordx4 v5, s[44:47], s3 offen offset:1024 lds
    v_and_b32 v18, 1, v0
    s_waitcnt lgkmcnt(0)
    v_mfma_f32_32x32x16_bf16 v[32:47], v[96:99], v[104:107], v[32:47]
    ds_read_b128 v[120:123], v25 offset:0
    ds_read_b64_tr_b16 v[112:113], v28 offset:20480
    ds_read_b64_tr_b16 v[114:115], v28 offset:21504
    s_lshl_b32 s61, s95, 8
    v_mfma_f32_32x32x16_bf16 v[48:63], v[100:103], v[104:107], v[48:63]
    ds_read_b128 v[124:127], v24 offset:4096
    ds_read_b64_tr_b16 v[116:117], v29 offset:20480
    ds_read_b64_tr_b16 v[118:119], v29 offset:21504
    s_mul_i32 s62, s87, 9280
    v_mfma_f32_32x32x16_bf16 v[80:95], v[100:103], v[108:111], v[80:95]
    buffer_load_dwordx4 v6, s[44:47], s3 offen offset:2048 lds
    s_add_u32 s62, s62, s61
    s_add_u32 s62, s62, 71392
    v_mfma_f32_32x32x16_bf16 v[64:79], v[96:99], v[108:111], v[64:79]
    buffer_load_dwordx4 v7, s[44:47], s3 offen offset:3072 lds
    v_lshl_add_u32 v17, v19, 4, s62
    s_waitcnt lgkmcnt(0)
    v_mfma_f32_32x32x16_bf16 v[32:47], v[112:115], v[120:123], v[32:47]
    ds_read_b128 v[104:107], v26 offset:0
    ds_read_b64_tr_b16 v[96:97], v28 offset:24576
    ds_read_b64_tr_b16 v[98:99], v28 offset:25600
    v_mul_u32_u24 v21, 4640, v18
    v_mfma_f32_32x32x16_bf16 v[48:63], v[116:119], v[120:123], v[48:63]
    ds_read_b128 v[108:111], v27 offset:4096
    ds_read_b64_tr_b16 v[100:101], v29 offset:24576
    ds_read_b64_tr_b16 v[102:103], v29 offset:25600
    v_lshl_add_u32 v21, v20, 6, v21
    v_mfma_f32_32x32x16_bf16 v[80:95], v[116:119], v[124:127], v[80:95]
    buffer_load_dwordx4 v[128:131], v30, s[48:51], 0 offen offset:0 sc1
    v_sub_u32 v17, v17, v21
    s_mul_i32 s62, s87, 8448
    v_mfma_f32_32x32x16_bf16 v[64:79], v[112:115], v[124:127], v[64:79]
    buffer_load_dwordx4 v[132:135], v30, s[48:51], 0 offen offset:512 sc1
    s_add_u32 s62, s62, s61
    s_waitcnt lgkmcnt(0)
    v_mfma_f32_32x32x16_bf16 v[32:47], v[96:99], v[104:107], v[32:47]
    ds_read_b128 v[120:123], v27 offset:0
    ds_read_b64_tr_b16 v[112:113], v28 offset:28672
    ds_read_b64_tr_b16 v[114:115], v28 offset:29696
    s_add_u32 s62, s62, 49224
    v_mfma_f32_32x32x16_bf16 v[48:63], v[100:103], v[104:107], v[48:63]
    ds_read_b128 v[124:127], v26 offset:4096
    ds_read_b64_tr_b16 v[116:117], v29 offset:28672
    ds_read_b64_tr_b16 v[118:119], v29 offset:29696
    v_mul_u32_u24 v21, 4224, v18
    v_mfma_f32_32x32x16_bf16 v[80:95], v[100:103], v[108:111], v[80:95]
    buffer_load_dwordx4 v[136:139], v31, s[48:51], s90 offen sc1
    v_lshl_add_u32 v21, v19, 4, v21
    v_lshl_add_u32 v21, v20, 3, v21
    v_mfma_f32_32x32x16_bf16 v[64:79], v[96:99], v[108:111], v[64:79]
    buffer_load_dwordx4 v[140:143], v31, s[48:51], s92 offen sc1
    s_add_u32 m0, s73, 32768
    s_lshl4_add_u32 s3, s75, s72
    s_waitcnt vmcnt(10) lgkmcnt(0)
    s_barrier
    v_mfma_f32_32x32x16_bf16 v[32:47], v[112:115], v[120:123], v[32:47]
    ds_read_b128 v[104:107], v24 offset:16384
    ds_read_b64_tr_b16 v[96:97], v28 offset:32768
    ds_read_b64_tr_b16 v[98:99], v28 offset:33792
    v_add_u32 v16, s62, v21
    v_mfma_f32_32x32x16_bf16 v[48:63], v[116:119], v[120:123], v[48:63]
    ds_read_b128 v[108:111], v25 offset:20480
    ds_read_b64_tr_b16 v[100:101], v29 offset:32768
    ds_read_b64_tr_b16 v[102:103], v29 offset:33792
    s_lshl_b32 s61, s95, 2
    v_mfma_f32_32x32x16_bf16 v[80:95], v[116:119], v[124:127], v[80:95]
    buffer_load_dwordx4 v4, s[44:47], s3 offen offset:0 lds
    s_sub_u32 s61, s84, s61
    v_mov_b32_e64 v18, s61
    v_mfma_f32_32x32x16_bf16 v[64:79], v[112:115], v[124:127], v[64:79]
    buffer_load_dwordx4 v5, s[44:47], s3 offen offset:1024 lds
    s_waitcnt lgkmcnt(0)
    v_mfma_f32_32x32x16_bf16 v[32:47], v[96:99], v[104:107], v[32:47]
    ds_read_b128 v[120:123], v25 offset:16384
    ds_read_b64_tr_b16 v[112:113], v28 offset:36864
    ds_read_b64_tr_b16 v[114:115], v28 offset:37888
    v_mfma_f32_32x32x16_bf16 v[48:63], v[100:103], v[104:107], v[48:63]
    ds_read_b128 v[124:127], v24 offset:20480
    ds_read_b64_tr_b16 v[116:117], v29 offset:36864
    ds_read_b64_tr_b16 v[118:119], v29 offset:37888
    v_mfma_f32_32x32x16_bf16 v[80:95], v[100:103], v[108:111], v[80:95]
    buffer_load_dwordx4 v6, s[44:47], s3 offen offset:2048 lds
    v_mfma_f32_32x32x16_bf16 v[64:79], v[96:99], v[108:111], v[64:79]
    buffer_load_dwordx4 v7, s[44:47], s3 offen offset:3072 lds
    s_add_u32 m0, s73, 114688
    s_lshl4_add_u32 s3, s76, s72
    s_waitcnt lgkmcnt(0)
    v_mfma_f32_32x32x16_bf16 v[32:47], v[112:115], v[120:123], v[32:47]
    ds_read_b128 v[104:107], v26 offset:16384
    ds_read_b64_tr_b16 v[96:97], v28 offset:40960
    ds_read_b64_tr_b16 v[98:99], v28 offset:41984
    v_mfma_f32_32x32x16_bf16 v[48:63], v[116:119], v[120:123], v[48:63]
    ds_read_b128 v[108:111], v27 offset:20480
    ds_read_b64_tr_b16 v[100:101], v29 offset:40960
    ds_read_b64_tr_b16 v[102:103], v29 offset:41984
    v_mfma_f32_32x32x16_bf16 v[80:95], v[116:119], v[124:127], v[80:95]
    buffer_load_dwordx4 v4, s[44:47], s3 offen offset:0 lds
    v_mfma_f32_32x32x16_bf16 v[64:79], v[112:115], v[124:127], v[64:79]
    buffer_load_dwordx4 v5, s[44:47], s3 offen offset:1024 lds
    s_waitcnt lgkmcnt(0)
    v_mfma_f32_32x32x16_bf16 v[32:47], v[96:99], v[104:107], v[32:47]
    ds_read_b128 v[120:123], v27 offset:16384
    ds_read_b64_tr_b16 v[112:113], v28 offset:45056
    ds_read_b64_tr_b16 v[114:115], v28 offset:46080
    v_mfma_f32_32x32x16_bf16 v[48:63], v[100:103], v[104:107], v[48:63]
    ds_read_b128 v[124:127], v26 offset:20480
    ds_read_b64_tr_b16 v[116:117], v29 offset:45056
    ds_read_b64_tr_b16 v[118:119], v29 offset:46080
    v_mfma_f32_32x32x16_bf16 v[80:95], v[100:103], v[108:111], v[80:95]
    buffer_load_dwordx4 v6, s[44:47], s3 offen offset:2048 lds
    v_mfma_f32_32x32x16_bf16 v[64:79], v[96:99], v[108:111], v[64:79]
    buffer_load_dwordx4 v7, s[44:47], s3 offen offset:3072 lds
    s_add_u32 m0, s73, 0
    s_lshl4_add_u32 s3, s77, s72
    s_waitcnt vmcnt(12) lgkmcnt(0)
    s_barrier
    v_mfma_f32_32x32x16_bf16 v[32:47], v[112:115], v[120:123], v[32:47]
    s_waitcnt vmcnt(8)
    v_bitop3_b32 v144, v131, v135, v2 bitop3:0x7e
    v_bitop3_b32 v145, v139, v143, v2 bitop3:0x7e
    v_bitop3_b32 v144, v145, v144, v3 bitop3:0xf4
    v_cmp_ne_u32 vcc, 0, v144
    s_cbranch_vccnz SLOW_REC
BACK_REC:
    v_mfma_f32_32x32x16_bf16 v[48:63], v[116:119], v[120:123], v[48:63]
    buffer_load_dwordx4 v4, s[44:47], s3 offen offset:0 lds
    v_mov_b32 v131, 0
    v_mov_b32_e64 v139, 0
    v_mfma_f32_32x32x16_bf16 v[80:95], v[116:119], v[124:127], v[80:95]
    ds_read_b64_tr_b16 a[0:1], v10 offset:0
    ds_read_b64_tr_b16 a[2:3], v10 offset:1024
    v_mov_b32 v135, 0
    v_mov_b32 v143, 0
    v_mfma_f32_32x32x16_bf16 v[64:79], v[112:115], v[124:127], v[64:79]
    buffer_load_dwordx4 v5, s[44:47], s3 offen offset:1024 lds
    ds_read_b64_tr_b16 a[4:5], v11 offset:0
    v_mfma_f32_32x32x16_bf16 v[32:47], v[128:131], v[136:139], v[32:47]
    ds_read_b64_tr_b16 a[6:7], v11 offset:1024
    ds_read_b64_tr_b16 a[8:9], v10 offset:2048
    ds_read_b64_tr_b16 a[10:11], v10 offset:3072
    v_mfma_f32_32x32x16_bf16 v[48:63], v[132:135], v[136:139], v[48:63]
    buffer_load_dwordx4 v6, s[44:47], s3 offen offset:2048 lds
    ds_read_b64_tr_b16 a[12:13], v11 offset:2048
    v_mfma_f32_32x32x16_bf16 v[64:79], v[128:131], v[140:143], v[64:79]
    ds_read_b64_tr_b16 a[14:15], v11 offset:3072
    ds_read_b64_tr_b16 a[16:17], v10 offset:8192
    ds_read_b64_tr_b16 a[18:19], v10 offset:9216
    v_mfma_f32_32x32x16_bf16 v[80:95], v[132:135], v[140:143], v[80:95]
    buffer_load_dwordx4 v7, s[44:47], s3 offen offset:3072 lds
    ds_read_b64_tr_b16 a[20:21], v11 offset:8192
    ds_read_b64_tr_b16 a[22:23], v11 offset:9216
    ds_read_b64_tr_b16 a[24:25], v10 offset:10240
    ds_read_b64_tr_b16 a[26:27], v10 offset:11264
    ds_read_b64_tr_b16 a[28:29], v11 offset:10240
    ds_read_b64_tr_b16 a[30:31], v11 offset:11264
    v_and_b32 v146, 0xffff0000, v137
    v_lshlrev_b32 v144, 16, v138
    v_add_f32 v146, v146, v144
    v_rcp_f32 v144, v146
    s_nop 0
    v_mul_f32 v148, 0xc0135761, v144
    v_mul_f32_e64 v145, v144, v144
    v_mul_f32 v144, 0xbdd2d3e8, v144
    v_mul_f32_e64 v149, v144, v145
    v_and_b32 v147, 0xffff0000, v141
    v_lshlrev_b32 v144, 16, v142
    v_add_f32 v147, v147, v144
    v_rcp_f32 v144, v147
    s_nop 0
    v_mul_f32 v150, 0xc0135761, v144
    v_mul_f32_e64 v145, v144, v144
    v_mul_f32 v144, 0xbdd2d3e8, v144
    v_mul_f32_e64 v151, v144, v145
    v_and_b32 v29, 0xffff0000, v142
    v_lshrrev_b32 v28, 16, v142
    v_sub_f32 v30, 1.0, v29
    v_cvt_pk_bf16_f32 v31, v30, 0
    v_lshlrev_b32_e64 v30, 16, v31
    buffer_load_dword v13, v14, s[48:51], 0 offen sc1
    v_pk_mul_f32 v[152:153], v[32:33], v[32:33]
    v_pk_mul_f32 v[154:155], v[34:35], v[34:35]
    v_pk_mul_f32 v[156:157], v[36:37], v[36:37]
    v_pk_mul_f32 v[158:159], v[38:39], v[38:39]
    v_pk_fma_f32 v[152:153], v[152:153], v[148:149], v[148:149] op_sel:[0,1,0] op_sel_hi:[1,1,0]
    v_pk_fma_f32 v[154:155], v[154:155], v[148:149], v[148:149] op_sel:[0,1,0] op_sel_hi:[1,1,0]
    v_pk_fma_f32 v[156:157], v[156:157], v[148:149], v[148:149] op_sel:[0,1,0] op_sel_hi:[1,1,0]
    v_pk_fma_f32 v[158:159], v[158:159], v[148:149], v[148:149] op_sel:[0,1,0] op_sel_hi:[1,1,0]
    v_pk_mul_f32 v[152:153], v[152:153], v[32:33]
    v_pk_mul_f32 v[154:155], v[154:155], v[34:35]
    v_pk_mul_f32 v[156:157], v[156:157], v[36:37]
    v_pk_mul_f32 v[158:159], v[158:159], v[38:39]
    v_exp_f32 v152, v152
    v_exp_f32 v153, v153
    v_exp_f32 v154, v154
    v_exp_f32 v155, v155
    v_exp_f32 v156, v156
    v_exp_f32 v157, v157
    v_exp_f32 v158, v158
    v_exp_f32 v159, v159
    v_pk_fma_f32 v[152:153], v[152:153], v[146:147], v[146:147] op_sel:[0,0,0] op_sel_hi:[1,0,0]
    v_pk_fma_f32 v[154:155], v[154:155], v[146:147], v[146:147] op_sel:[0,0,0] op_sel_hi:[1,0,0]
    v_pk_fma_f32 v[156:157], v[156:157], v[146:147], v[146:147] op_sel:[0,0,0] op_sel_hi:[1,0,0]
    v_pk_fma_f32 v[158:159], v[158:159], v[146:147], v[146:147] op_sel:[0,0,0] op_sel_hi:[1,0,0]
    v_rcp_f32 v152, v152
    v_rcp_f32 v153, v153
    v_rcp_f32 v154, v154
    v_rcp_f32 v155, v155
    v_rcp_f32 v156, v156
    v_rcp_f32 v157, v157
    v_rcp_f32 v158, v158
    v_rcp_f32 v159, v159
    v_pk_mul_f32 v[152:153], v[152:153], v[32:33]
    v_pk_mul_f32 v[154:155], v[154:155], v[34:35]
    v_pk_mul_f32 v[156:157], v[156:157], v[36:37]
    v_pk_mul_f32 v[158:159], v[158:159], v[38:39]
    v_cvt_pk_bf16_f32 v224, v152, v153
    v_cvt_pk_bf16_f32 v225, v154, v155
    v_cvt_pk_bf16_f32 v226, v156, v157
    v_cvt_pk_bf16_f32 v227, v158, v159
    buffer_store_dwordx4 v[224:227], v1, s[48:51], s91 offen offset:0 sc1
    v_pk_mul_f32 v[152:153], v[40:41], v[40:41]
    v_pk_mul_f32 v[154:155], v[42:43], v[42:43]
    v_pk_mul_f32 v[156:157], v[44:45], v[44:45]
    v_pk_mul_f32 v[158:159], v[46:47], v[46:47]
    v_pk_fma_f32 v[152:153], v[152:153], v[148:149], v[148:149] op_sel:[0,1,0] op_sel_hi:[1,1,0]
    v_pk_fma_f32 v[154:155], v[154:155], v[148:149], v[148:149] op_sel:[0,1,0] op_sel_hi:[1,1,0]
    v_pk_fma_f32 v[156:157], v[156:157], v[148:149], v[148:149] op_sel:[0,1,0] op_sel_hi:[1,1,0]
    v_pk_fma_f32 v[158:159], v[158:159], v[148:149], v[148:149] op_sel:[0,1,0] op_sel_hi:[1,1,0]
    v_pk_mul_f32 v[152:153], v[152:153], v[40:41]
    v_pk_mul_f32 v[154:155], v[154:155], v[42:43]
    v_pk_mul_f32 v[156:157], v[156:157], v[44:45]
    v_pk_mul_f32 v[158:159], v[158:159], v[46:47]
    v_exp_f32 v152, v152
    v_exp_f32 v153, v153
    v_exp_f32 v154, v154
    v_exp_f32 v155, v155
    v_exp_f32 v156, v156
    v_exp_f32 v157, v157
    v_exp_f32 v158, v158
    v_exp_f32 v159, v159
    v_pk_fma_f32 v[152:153], v[152:153], v[146:147], v[146:147] op_sel:[0,0,0] op_sel_hi:[1,0,0]
    v_pk_fma_f32 v[154:155], v[154:155], v[146:147], v[146:147] op_sel:[0,0,0] op_sel_hi:[1,0,0]
    v_pk_fma_f32 v[156:157], v[156:157], v[146:147], v[146:147] op_sel:[0,0,0] op_sel_hi:[1,0,0]
    v_pk_fma_f32 v[158:159], v[158:159], v[146:147], v[146:147] op_sel:[0,0,0] op_sel_hi:[1,0,0]
    v_rcp_f32 v152, v152
    v_rcp_f32 v153, v153
    v_rcp_f32 v154, v154
    v_rcp_f32 v155, v155
    v_rcp_f32 v156, v156
    v_rcp_f32 v157, v157
    v_rcp_f32 v158, v158
    v_rcp_f32 v159, v159
    v_pk_mul_f32 v[152:153], v[152:153], v[40:41]
    v_pk_mul_f32 v[154:155], v[154:155], v[42:43]
    v_pk_mul_f32 v[156:157], v[156:157], v[44:45]
    v_pk_mul_f32 v[158:159], v[158:159], v[46:47]
    v_cvt_pk_bf16_f32 v228, v152, v153
    v_cvt_pk_bf16_f32 v229, v154, v155
    v_cvt_pk_bf16_f32 v230, v156, v157
    v_cvt_pk_bf16_f32 v231, v158, v159
    buffer_store_dwordx4 v[228:231], v1, s[48:51], s91 offen offset:1024 sc1
    v_pk_mul_f32 v[152:153], v[48:49], v[48:49]
    v_pk_mul_f32 v[154:155], v[50:51], v[50:51]
    v_pk_mul_f32 v[156:157], v[52:53], v[52:53]
    v_pk_mul_f32 v[158:159], v[54:55], v[54:55]
    v_pk_fma_f32 v[152:153], v[152:153], v[148:149], v[148:149] op_sel:[0,1,0] op_sel_hi:[1,1,0]
    v_pk_fma_f32 v[154:155], v[154:155], v[148:149], v[148:149] op_sel:[0,1,0] op_sel_hi:[1,1,0]
    v_pk_fma_f32 v[156:157], v[156:157], v[148:149], v[148:149] op_sel:[0,1,0] op_sel_hi:[1,1,0]
    v_pk_fma_f32 v[158:159], v[158:159], v[148:149], v[148:149] op_sel:[0,1,0] op_sel_hi:[1,1,0]
    v_pk_mul_f32 v[152:153], v[152:153], v[48:49]
    v_pk_mul_f32 v[154:155], v[154:155], v[50:51]
    v_pk_mul_f32 v[156:157], v[156:157], v[52:53]
    v_pk_mul_f32 v[158:159], v[158:159], v[54:55]
    v_exp_f32 v152, v152
    v_exp_f32 v153, v153
    v_exp_f32 v154, v154
    v_exp_f32 v155, v155
    v_exp_f32 v156, v156
    v_exp_f32 v157, v157
    v_exp_f32 v158, v158
    v_exp_f32 v159, v159
    v_pk_fma_f32 v[152:153], v[152:153], v[146:147], v[146:147] op_sel:[0,0,0] op_sel_hi:[1,0,0]
    v_pk_fma_f32 v[154:155], v[154:155], v[146:147], v[146:147] op_sel:[0,0,0] op_sel_hi:[1,0,0]
    v_pk_fma_f32 v[156:157], v[156:157], v[146:147], v[146:147] op_sel:[0,0,0] op_sel_hi:[1,0,0]
    v_pk_fma_f32 v[158:159], v[158:159], v[146:147], v[146:147] op_sel:[0,0,0] op_sel_hi:[1,0,0]
    v_rcp_f32 v152, v152
    v_rcp_f32 v153, v153
    v_rcp_f32 v154, v154
    v_rcp_f32 v155, v155
    v_rcp_f32 v156, v156
    v_rcp_f32 v157, v157
    v_rcp_f32 v158, v158
    v_rcp_f32 v159, v159
    v_pk_mul_f32 v[152:153], v[152:153], v[48:49]
    v_pk_mul_f32 v[154:155], v[154:155], v[50:51]
    v_pk_mul_f32 v[156:157], v[156:157], v[52:53]
    v_pk_mul_f32 v[158:159], v[158:159], v[54:55]
    v_cvt_pk_bf16_f32 v232, v152, v153
    v_cvt_pk_bf16_f32 v233, v154, v155
    v_cvt_pk_bf16_f32 v234, v156, v157
    v_cvt_pk_bf16_f32 v235, v158, v159
    buffer_store_dwordx4 v[232:235], v1, s[48:51], s91 offen offset:2048 sc1
    v_pk_mul_f32 v[152:153], v[56:57], v[56:57]
    v_pk_mul_f32 v[154:155], v[58:59], v[58:59]
    v_pk_mul_f32 v[156:157], v[60:61], v[60:61]
    v_pk_mul_f32 v[158:159], v[62:63], v[62:63]
    v_pk_fma_f32 v[152:153], v[152:153], v[148:149], v[148:149] op_sel:[0,1,0] op_sel_hi:[1,1,0]
    v_pk_fma_f32 v[154:155], v[154:155], v[148:149], v[148:149] op_sel:[0,1,0] op_sel_hi:[1,1,0]
    v_pk_fma_f32 v[156:157], v[156:157], v[148:149], v[148:149] op_sel:[0,1,0] op_sel_hi:[1,1,0]
    v_pk_fma_f32 v[158:159], v[158:159], v[148:149], v[148:149] op_sel:[0,1,0] op_sel_hi:[1,1,0]
    v_pk_mul_f32 v[152:153], v[152:153], v[56:57]
    v_pk_mul_f32 v[154:155], v[154:155], v[58:59]
    v_pk_mul_f32 v[156:157], v[156:157], v[60:61]
    v_pk_mul_f32 v[158:159], v[158:159], v[62:63]
    v_exp_f32 v152, v152
    v_exp_f32 v153, v153
    v_exp_f32 v154, v154
    v_exp_f32 v155, v155
    v_exp_f32 v156, v156
    v_exp_f32 v157, v157
    v_exp_f32 v158, v158
    v_exp_f32 v159, v159
    v_pk_fma_f32 v[152:153], v[152:153], v[146:147], v[146:147] op_sel:[0,0,0] op_sel_hi:[1,0,0]
    v_pk_fma_f32 v[154:155], v[154:155], v[146:147], v[146:147] op_sel:[0,0,0] op_sel_hi:[1,0,0]
    v_pk_fma_f32 v[156:157], v[156:157], v[146:147], v[146:147] op_sel:[0,0,0] op_sel_hi:[1,0,0]
    v_pk_fma_f32 v[158:159], v[158:159], v[146:147], v[146:147] op_sel:[0,0,0] op_sel_hi:[1,0,0]
    v_rcp_f32 v152, v152
    v_rcp_f32 v153, v153
    v_rcp_f32 v154, v154
    v_rcp_f32 v155, v155
    v_rcp_f32 v156, v156
    v_rcp_f32 v157, v157
    v_rcp_f32 v158, v158
    v_rcp_f32 v159, v159
    v_pk_mul_f32 v[152:153], v[152:153], v[56:57]
    v_pk_mul_f32 v[154:155], v[154:155], v[58:59]
    v_pk_mul_f32 v[156:157], v[156:157], v[60:61]
    v_pk_mul_f32 v[158:159], v[158:159], v[62:63]
    v_cvt_pk_bf16_f32 v236, v152, v153
    v_cvt_pk_bf16_f32 v237, v154, v155
    v_cvt_pk_bf16_f32 v238, v156, v157
    v_cvt_pk_bf16_f32 v239, v158, v159
    s_waitcnt vmcnt(3)
    v_cmp_ne_u32 vcc, v13, v2
    s_nop 0
    s_and_b64 vcc, vcc, s[14:15]
    s_cbranch_vccnz SLOW_FU
BACK_FU:
    s_barrier
    s_lshl1_add_u32 s61, s2, s87
    s_lshl_b32 s61, s61, 12
    s_lshl2_add_u32 s61, s95, s61
    s_add_u32 s3, s61, 8388604
    s_mov_b32 m0, s84
    s_nop 0
    buffer_load_dwordx4 v1, s[48:51], s3 offen offset:0 sc1 lds
    v_pk_mul_f32 v[152:153], v[64:65], v[64:65]
    v_pk_mul_f32 v[154:155], v[66:67], v[66:67]
    v_pk_mul_f32 v[156:157], v[68:69], v[68:69]
    v_pk_mul_f32 v[158:159], v[70:71], v[70:71]
    v_pk_fma_f32 v[152:153], v[152:153], v[150:151], v[150:151] op_sel:[0,1,0] op_sel_hi:[1,1,0]
    v_pk_fma_f32 v[154:155], v[154:155], v[150:151], v[150:151] op_sel:[0,1,0] op_sel_hi:[1,1,0]
    v_pk_fma_f32 v[156:157], v[156:157], v[150:151], v[150:151] op_sel:[0,1,0] op_sel_hi:[1,1,0]
    v_pk_fma_f32 v[158:159], v[158:159], v[150:151], v[150:151] op_sel:[0,1,0] op_sel_hi:[1,1,0]
    buffer_load_dwordx4 v1, s[48:51], s3 offen offset:1024 sc1 lds
    v_pk_mul_f32 v[152:153], v[152:153], v[64:65]
    v_pk_mul_f32 v[154:155], v[154:155], v[66:67]
    v_pk_mul_f32 v[156:157], v[156:157], v[68:69]
    v_pk_mul_f32 v[158:159], v[158:159], v[70:71]
    v_exp_f32 v152, v152
    v_exp_f32 v153, v153
    v_exp_f32 v154, v154
    v_exp_f32_e64 v155, v155
    buffer_load_dwordx4 v1, s[48:51], s3 offen offset:2048 sc1 lds
    v_exp_f32 v156, v156
    v_exp_f32 v157, v157
    v_exp_f32 v158, v158
    v_exp_f32 v159, v159
    v_pk_fma_f32 v[152:153], v[152:153], v[146:147], v[146:147] op_sel:[0,1,1] op_sel_hi:[1,1,1]
    v_pk_fma_f32 v[154:155], v[154:155], v[146:147], v[146:147] op_sel:[0,1,1] op_sel_hi:[1,1,1]
    v_pk_fma_f32 v[156:157], v[156:157], v[146:147], v[146:147] op_sel:[0,1,1] op_sel_hi:[1,1,1]
    v_pk_fma_f32 v[158:159], v[158:159], v[146:147], v[146:147] op_sel:[0,1,1] op_sel_hi:[1,1,1]
    buffer_load_dwordx4 v1, s[48:51], s3 offen offset:3072 sc1 lds
    v_rcp_f32 v152, v152
    v_rcp_f32 v153, v153
    v_rcp_f32 v154, v154
    v_rcp_f32 v155, v155
    v_rcp_f32 v156, v156
    v_rcp_f32 v157, v157
    v_rcp_f32 v158, v158
    v_rcp_f32 v159, v159
    buffer_store_dwordx4 v[236:239], v1, s[48:51], s91 offen offset:3072 sc1
    v_pk_mul_f32 v[152:153], v[152:153], v[64:65]
    v_pk_mul_f32 v[154:155], v[154:155], v[66:67]
    v_pk_mul_f32 v[156:157], v[156:157], v[68:69]
    v_pk_mul_f32 v[158:159], v[158:159], v[70:71]
    v_cvt_pk_bf16_f32 v240, v152, v153
    v_cvt_pk_bf16_f32 v241, v154, v155
    v_cvt_pk_bf16_f32 v242, v156, v157
    v_cvt_pk_bf16_f32 v243, v158, v159
    s_add_u32 s91, s91, 114688
    buffer_store_dwordx4 v[240:243], v1, s[48:51], s91 offen offset:0 sc1
    v_pk_mul_f32 v[152:153], v[72:73], v[72:73]
    v_pk_mul_f32 v[154:155], v[74:75], v[74:75]
    v_pk_mul_f32 v[156:157], v[76:77], v[76:77]
    v_pk_mul_f32 v[158:159], v[78:79], v[78:79]
    v_pk_fma_f32 v[152:153], v[152:153], v[150:151], v[150:151] op_sel:[0,1,0] op_sel_hi:[1,1,0]
    v_pk_fma_f32 v[154:155], v[154:155], v[150:151], v[150:151] op_sel:[0,1,0] op_sel_hi:[1,1,0]
    v_pk_fma_f32 v[156:157], v[156:157], v[150:151], v[150:151] op_sel:[0,1,0] op_sel_hi:[1,1,0]
    v_pk_fma_f32 v[158:159], v[158:159], v[150:151], v[150:151] op_sel:[0,1,0] op_sel_hi:[1,1,0]
    v_pk_mul_f32 v[152:153], v[152:153], v[72:73]
    v_pk_mul_f32 v[154:155], v[154:155], v[74:75]
    v_pk_mul_f32 v[156:157], v[156:157], v[76:77]
    v_pk_mul_f32 v[158:159], v[158:159], v[78:79]
    v_exp_f32 v152, v152
    v_exp_f32 v153, v153
    v_exp_f32 v154, v154
    v_exp_f32 v155, v155
    v_exp_f32 v156, v156
    v_exp_f32 v157, v157
    v_exp_f32 v158, v158
    v_exp_f32 v159, v159
    v_pk_fma_f32 v[152:153], v[152:153], v[146:147], v[146:147] op_sel:[0,1,1] op_sel_hi:[1,1,1]
    v_pk_fma_f32 v[154:155], v[154:155], v[146:147], v[146:147] op_sel:[0,1,1] op_sel_hi:[1,1,1]
    v_pk_fma_f32 v[156:157], v[156:157], v[146:147], v[146:147] op_sel:[0,1,1] op_sel_hi:[1,1,1]
    v_pk_fma_f32 v[158:159], v[158:159], v[146:147], v[146:147] op_sel:[0,1,1] op_sel_hi:[1,1,1]
    v_rcp_f32 v152, v152
    v_rcp_f32 v153, v153
    v_rcp_f32 v154, v154
    v_rcp_f32 v155, v155
    v_rcp_f32 v156, v156
    v_rcp_f32 v157, v157
    v_rcp_f32 v158, v158
    v_rcp_f32 v159, v159
    v_pk_mul_f32 v[152:153], v[152:153], v[72:73]
    v_pk_mul_f32 v[154:155], v[154:155], v[74:75]
    v_pk_mul_f32 v[156:157], v[156:157], v[76:77]
    v_pk_mul_f32 v[158:159], v[158:159], v[78:79]
    v_cvt_pk_bf16_f32 v244, v152, v153
    v_cvt_pk_bf16_f32 v245, v154, v155
    v_cvt_pk_bf16_f32 v246, v156, v157
    v_cvt_pk_bf16_f32 v247, v158, v159
    buffer_store_dwordx4 v[244:247], v1, s[48:51], s91 offen offset:1024 sc1
    v_pk_mul_f32 v[152:153], v[80:81], v[80:81]
    v_pk_mul_f32 v[154:155], v[82:83], v[82:83]
    v_pk_mul_f32 v[156:157], v[84:85], v[84:85]
    v_pk_mul_f32 v[158:159], v[86:87], v[86:87]
    v_pk_fma_f32 v[152:153], v[152:153], v[150:151], v[150:151] op_sel:[0,1,0] op_sel_hi:[1,1,0]
    v_pk_fma_f32 v[154:155], v[154:155], v[150:151], v[150:151] op_sel:[0,1,0] op_sel_hi:[1,1,0]
    v_pk_fma_f32 v[156:157], v[156:157], v[150:151], v[150:151] op_sel:[0,1,0] op_sel_hi:[1,1,0]
    v_pk_fma_f32 v[158:159], v[158:159], v[150:151], v[150:151] op_sel:[0,1,0] op_sel_hi:[1,1,0]
    v_pk_mul_f32 v[152:153], v[152:153], v[80:81]
    v_pk_mul_f32 v[154:155], v[154:155], v[82:83]
    v_pk_mul_f32 v[156:157], v[156:157], v[84:85]
    v_pk_mul_f32 v[158:159], v[158:159], v[86:87]
    v_exp_f32 v152, v152
    v_exp_f32 v153, v153
    v_exp_f32 v154, v154
    v_exp_f32 v155, v155
    v_exp_f32 v156, v156
    v_exp_f32 v157, v157
    v_exp_f32 v158, v158
    v_exp_f32 v159, v159
    v_pk_fma_f32 v[152:153], v[152:153], v[146:147], v[146:147] op_sel:[0,1,1] op_sel_hi:[1,1,1]
    v_pk_fma_f32 v[154:155], v[154:155], v[146:147], v[146:147] op_sel:[0,1,1] op_sel_hi:[1,1,1]
    v_pk_fma_f32 v[156:157], v[156:157], v[146:147], v[146:147] op_sel:[0,1,1] op_sel_hi:[1,1,1]
    v_pk_fma_f32 v[158:159], v[158:159], v[146:147], v[146:147] op_sel:[0,1,1] op_sel_hi:[1,1,1]
    v_rcp_f32 v152, v152
    v_rcp_f32 v153, v153
    v_rcp_f32 v154, v154
    v_rcp_f32 v155, v155
    v_rcp_f32 v156, v156
    v_rcp_f32 v157, v157
    v_rcp_f32 v158, v158
    v_rcp_f32 v159, v159
    v_pk_mul_f32 v[152:153], v[152:153], v[80:81]
    v_pk_mul_f32 v[154:155], v[154:155], v[82:83]
    v_pk_mul_f32 v[156:157], v[156:157], v[84:85]
    v_pk_mul_f32 v[158:159], v[158:159], v[86:87]
    v_cvt_pk_bf16_f32 v248, v152, v153
    v_cvt_pk_bf16_f32 v249, v154, v155
    v_cvt_pk_bf16_f32 v250, v156, v157
    v_cvt_pk_bf16_f32 v251, v158, v159
    buffer_store_dwordx4 v[248:251], v1, s[48:51], s91 offen offset:2048 sc1
    v_pk_mul_f32 v[152:153], v[88:89], v[88:89]
    v_pk_mul_f32 v[154:155], v[90:91], v[90:91]
    v_pk_mul_f32 v[156:157], v[92:93], v[92:93]
    v_pk_mul_f32 v[158:159], v[94:95], v[94:95]
    v_pk_fma_f32 v[152:153], v[152:153], v[150:151], v[150:151] op_sel:[0,1,0] op_sel_hi:[1,1,0]
    v_pk_fma_f32 v[154:155], v[154:155], v[150:151], v[150:151] op_sel:[0,1,0] op_sel_hi:[1,1,0]
    v_pk_fma_f32 v[156:157], v[156:157], v[150:151], v[150:151] op_sel:[0,1,0] op_sel_hi:[1,1,0]
    v_pk_fma_f32 v[158:159], v[158:159], v[150:151], v[150:151] op_sel:[0,1,0] op_sel_hi:[1,1,0]
    v_pk_mul_f32 v[152:153], v[152:153], v[88:89]
    v_pk_mul_f32 v[154:155], v[154:155], v[90:91]
    v_pk_mul_f32 v[156:157], v[156:157], v[92:93]
    v_pk_mul_f32 v[158:159], v[158:159], v[94:95]
    v_exp_f32 v152, v152
    v_exp_f32 v153, v153
    v_exp_f32 v154, v154
    v_exp_f32 v155, v155
    v_exp_f32 v156, v156
    v_exp_f32 v157, v157
    v_exp_f32 v158, v158
    v_exp_f32 v159, v159
    v_pk_fma_f32 v[152:153], v[152:153], v[146:147], v[146:147] op_sel:[0,1,1] op_sel_hi:[1,1,1]
    v_pk_fma_f32 v[154:155], v[154:155], v[146:147], v[146:147] op_sel:[0,1,1] op_sel_hi:[1,1,1]
    v_pk_fma_f32 v[156:157], v[156:157], v[146:147], v[146:147] op_sel:[0,1,1] op_sel_hi:[1,1,1]
    v_pk_fma_f32 v[158:159], v[158:159], v[146:147], v[146:147] op_sel:[0,1,1] op_sel_hi:[1,1,1]
    v_rcp_f32 v152, v152
    v_rcp_f32 v153, v153
    v_rcp_f32 v154, v154
    v_rcp_f32 v155, v155
    v_rcp_f32 v156, v156
    v_rcp_f32 v157, v157
    v_rcp_f32 v158, v158
    v_rcp_f32 v159, v159
    v_pk_mul_f32 v[152:153], v[152:153], v[88:89]
    v_pk_mul_f32 v[154:155], v[154:155], v[90:91]
    v_pk_mul_f32 v[156:157], v[156:157], v[92:93]
    v_pk_mul_f32 v[158:159], v[158:159], v[94:95]
    v_cvt_pk_bf16_f32 v252, v152, v153
    v_cvt_pk_bf16_f32 v253, v154, v155
    v_cvt_pk_bf16_f32 v254, v156, v157
    v_cvt_pk_bf16_f32 v255, v158, v159
    buffer_store_dwordx4 v[252:255], v1, s[48:51], s91 offen offset:3072 sc1
    ds_write_b32 v218, v217
L_JOIN:
    s_waitcnt vmcnt(5)
    ds_write_b32 v18, v12
    s_waitcnt lgkmcnt(0)
    s_barrier
    ds_read_b64 v[96:97], v16 offset:0
    ds_read_b64 v[98:99], v16 offset:8
    ds_read_b128 v[100:103], v17 offset:3584
    ds_read_b64 v[104:105], v16 offset:512
    ds_read_b64 v[106:107], v16 offset:520
    ds_read_b128 v[108:111], v17 offset:3072
    ds_read_b64 v[112:113], v16 offset:1024
    ds_read_b64 v[114:115], v16 offset:1032
    ds_read_b128 v[116:119], v17 offset:2560
    s_waitcnt lgkmcnt(6)
    v_mfma_f32_16x16x32_bf16 v[64:67], v[96:99], v[100:103], 0
    ds_read_b64 v[120:121], v16 offset:1536
    ds_read_b64 v[122:123], v16 offset:1544
    s_waitcnt lgkmcnt(5)
    v_mfma_f32_16x16x32_bf16 v[68:71], v[104:107], v[100:103], 0
    ds_read_b128 v[124:127], v17 offset:2048
    v_min_u32 v18, 6, v0
    v_mfma_f32_16x16x32_bf16 v[68:71], v[96:99], v[108:111], v[68:71]
    s_waitcnt vmcnt(4)
    s_mov_b64 exec, 0xff
    buffer_store_dwordx4 v[2:5], v1, s[48:51], s18 offen offset:0 sc1
    s_mov_b64 exec, -1
    v_mfma_f32_16x16x32_bf16 v[72:75], v[104:107], v[108:111], 0
    ds_read_b64_tr_b16 a[32:33], v8 offset:32768
    s_waitcnt lgkmcnt(4)
    v_mfma_f32_16x16x32_bf16 v[72:75], v[112:115], v[100:103], v[72:75]
    s_add_u32 m0, s73, 131072
    s_lshl4_add_u32 s3, s78, s72
    buffer_load_dwordx4 v4, s[44:47], s3 offen offset:0 lds
    v_mfma_f32_16x16x32_bf16 v[76:79], v[112:115], v[108:111], 0
    ds_read_b64_tr_b16 a[34:35], v8 offset:33792
    s_mul_i32 s61, s57, 14
    v_mfma_f32_16x16x32_bf16 v[72:75], v[96:99], v[116:119], v[72:75]
    ds_read_b64 v[128:129], v16 offset:2048
    s_add_u32 s61, s61, s95
    v_mfma_f32_16x16x32_bf16 v[76:79], v[104:107], v[116:119], v[76:79]
    ds_read_b64 v[130:131], v16 offset:2056
    s_lshl_b32 s62, s83, 5
    v_mfma_f32_16x16x32_bf16 v[80:83], v[112:115], v[116:119], 0
    buffer_load_dwordx4 v5, s[44:47], s3 offen offset:1024 lds
    s_waitcnt lgkmcnt(4)
    v_mfma_f32_16x16x32_bf16 v[76:79], v[120:123], v[100:103], v[76:79]
    ds_read_b128 v[132:135], v17 offset:1536
    s_add_u32 s61, s61, s62
    v_mfma_f32_16x16x32_bf16 v[80:83], v[120:123], v[108:111], v[80:83]
    ds_read_b64 v[136:137], v16 offset:2560
    s_lshl_b32 s61, s61, 8
    v_mfma_f32_16x16x32_bf16 v[84:87], v[120:123], v[116:119], 0
    ds_read_b64 v[138:139], v16 offset:2568
    s_add_u32 s61, s61, 14942208
    v_mfma_f32_16x16x32_bf16 v[76:79], v[96:99], v[124:127], v[76:79]
    buffer_load_dwordx4 v6, s[44:47], s3 offen offset:2048 lds
    v_mfma_f32_16x16x32_bf16 v[80:83], v[104:107], v[124:127], v[80:83]
    ds_read_b128 v[140:143], v17 offset:1024
    v_lshl_add_u32 v18, v18, 9, s61
    v_mfma_f32_16x16x32_bf16 v[84:87], v[112:115], v[124:127], v[84:87]
    ds_read_b64 v[144:145], v16 offset:3072
    s_bfm_b64 s[14:15], 7, 0
    v_mfma_f32_16x16x32_bf16 v[88:91], v[120:123], v[124:127], 0
    ds_read_b64 v[146:147], v16 offset:3080
    s_waitcnt lgkmcnt(5)
    v_mfma_f32_16x16x32_bf16 v[80:83], v[128:131], v[100:103], v[80:83]
    buffer_load_dwordx4 v7, s[44:47], s3 offen offset:3072 lds
    v_mfma_f32_16x16x32_bf16 v[84:87], v[128:131], v[108:111], v[84:87]
    ds_read_b128 v[148:151], v17 offset:512
    v_cndmask_b32 v18, -1, v18, s[14:15]
    v_mfma_f32_16x16x32_bf16 v[88:91], v[128:131], v[116:119], v[88:91]
    ds_read_b64 v[152:153], v16 offset:3584
    s_lshl2_add_u32 s61, s82, s56
    v_mfma_f32_16x16x32_bf16 v[92:95], v[128:131], v[124:127], 0
    ds_read_b64 v[154:155], v16 offset:3592
    s_lshl_b32 s61, s61, 10
    v_mfma_f32_16x16x32_bf16 v[80:83], v[96:99], v[132:135], v[80:83]
    s_add_u32 m0, s73, 16384
    s_lshl4_add_u32 s3, s79, s72
    buffer_load_dwordx4 v4, s[44:47], s3 offen offset:0 lds
    v_mfma_f32_16x16x32_bf16 v[84:87], v[104:107], v[132:135], v[84:87]
    ds_read_b128 v[156:159], v17 offset:0
IW2:
    s_cbranch_execz IWBACK
    s_nop 0
    s_add_u32 s88, s61, 14810112
    v_mfma_f32_16x16x32_bf16 v[88:91], v[112:115], v[132:135], v[88:91]
    ds_read_b64 v[160:161], v16 offset:64
    v_bfe_u32 v3, v0, 4, 1
    v_mfma_f32_16x16x32_bf16 v[92:95], v[120:123], v[132:135], v[92:95]
    ds_read_b64 v[162:163], v16 offset:72
    s_waitcnt lgkmcnt(8)
    v_mfma_f32_16x16x32_bf16 v[84:87], v[136:139], v[100:103], v[84:87]
    buffer_load_dwordx4 v5, s[44:47], s3 offen offset:1024 lds
    v_mfma_f32_16x16x32_bf16 v[88:91], v[136:139], v[108:111], v[88:91]
    ds_read_b128 v[164:167], v17 offset:3648
    v_lshlrev_b32_e64 v3, 7, v3
    v_mfma_f32_16x16x32_bf16 v[92:95], v[136:139], v[116:119], v[92:95]
    ds_read_b64 v[168:169], v16 offset:576
    v_xor_b32_e64 v20, v1, v3
    v_mfma_f32_16x16x32_bf16 v[84:87], v[96:99], v[140:143], v[84:87]
    ds_read_b64 v[170:171], v16 offset:584
    s_lshl1_add_u32 s61, s73, 49152
    v_mfma_f32_16x16x32_bf16 v[88:91], v[104:107], v[140:143], v[88:91]
    buffer_load_dwordx4 v6, s[44:47], s3 offen offset:2048 lds
    v_mfma_f32_16x16x32_bf16 v[92:95], v[112:115], v[140:143], v[92:95]
    ds_read_b128 v[172:175], v17 offset:3136
    s_waitcnt lgkmcnt(9)
    v_mfma_f32_16x16x32_bf16 v[88:91], v[144:147], v[100:103], v[88:91]
    ds_read_b64 v[176:177], v16 offset:1088
    v_add_u32 v20, s61, v20
    v_mfma_f32_16x16x32_bf16 v[92:95], v[144:147], v[108:111], v[92:95]
    ds_read_b64 v[178:179], v16 offset:1096
    v_mfma_f32_16x16x32_bf16 v[88:91], v[96:99], v[148:151], v[88:91]
    buffer_load_dwordx4 v7, s[44:47], s3 offen offset:3072 lds
    v_mfma_f32_16x16x32_bf16 v[92:95], v[104:107], v[148:151], v[92:95]
    ds_read_b128 v[180:183], v17 offset:2624
    s_waitcnt lgkmcnt(9)
    v_mfma_f32_16x16x32_bf16 v[92:95], v[152:155], v[100:103], v[92:95]
    ds_read_b64_tr_b16 a[36:37], v9 offset:32768
    v_mfma_f32_16x16x32_bf16 v[92:95], v[96:99], v[156:159], v[92:95]
    ds_read_b64 v[184:185], v16 offset:1600
    s_waitcnt lgkmcnt(8)
    v_mfma_f32_16x16x32_bf16 v[64:67], v[160:163], v[164:167], v[64:67]
    s_add_u32 m0, s73, 147456
    s_lshl4_add_u32 s3, s80, s72
    buffer_load_dwordx4 v4, s[44:47], s3 offen offset:0 lds
    s_waitcnt lgkmcnt(5)
    v_mfma_f32_16x16x32_bf16 v[68:71], v[168:171], v[164:167], v[68:71]
    ds_read_b64 v[186:187], v16 offset:1608
    v_mfma_f32_16x16x32_bf16 v[68:71], v[160:163], v[172:175], v[68:71]
    ds_read_b128 v[188:191], v17 offset:2112
    v_mfma_f32_16x16x32_bf16 v[72:75], v[168:171], v[172:175], v[72:75]
    ds_read_b64_tr_b16 a[38:39], v9 offset:33792
    s_waitcnt lgkmcnt(5)
    v_mfma_f32_16x16x32_bf16 v[72:75], v[176:179], v[164:167], v[72:75]
    buffer_load_dwordx4 v5, s[44:47], s3 offen offset:1024 lds
    s_mov_b64 exec, 0xff00
    v_lshl_add_u32 v18, v0, 7, s88
    s_mov_b64 exec, -1
    v_mfma_f32_16x16x32_bf16 v[76:79], v[176:179], v[172:175], v[76:79]
    ds_read_b64 v[32:33], v16 offset:2112
    v_mfma_f32_16x16x32_bf16 v[72:75], v[160:163], v[180:183], v[72:75]
    buffer_load_dword v19, v18, s[48:51], 0 offen offset:0 sc1
    v_mfma_f32_16x16x32_bf16 v[76:79], v[168:171], v[180:183], v[76:79]
    ds_read_b64 v[34:35], v16 offset:2120
    v_mfma_f32_16x16x32_bf16 v[80:83], v[176:179], v[180:183], v[80:83]
    buffer_load_dwordx4 v6, s[44:47], s3 offen offset:2048 lds
    s_waitcnt lgkmcnt(3)
    v_mfma_f32_16x16x32_bf16 v[76:79], v[184:187], v[164:167], v[76:79]
    ds_read_b128 v[36:39], v17 offset:1600
    v_mfma_f32_16x16x32_bf16 v[80:83], v[184:187], v[172:175], v[80:83]
    ds_read_b64_tr_b16 a[40:41], v8 offset:34816
    v_mfma_f32_16x16x32_bf16 v[84:87], v[184:187], v[180:183], v[84:87]
    ds_read_b64_tr_b16 a[42:43], v8 offset:35840
    v_mfma_f32_16x16x32_bf16 v[76:79], v[160:163], v[188:191], v[76:79]
    buffer_load_dwordx4 v7, s[44:47], s3 offen offset:3072 lds
    v_mfma_f32_16x16x32_bf16 v[80:83], v[168:171], v[188:191], v[80:83]
    ds_read_b64_tr_b16 a[44:45], v9 offset:34816
    v_lshrrev_b32 v21, 3, v0
    v_mfma_f32_16x16x32_bf16 v[84:87], v[176:179], v[188:191], v[84:87]
    ds_read_b64 v[40:41], v16 offset:2624
    v_and_b32_e64 v3, 1, v0
    v_mfma_f32_16x16x32_bf16 v[88:91], v[184:187], v[188:191], v[88:91]
    ds_read_b64 v[42:43], v16 offset:2632
    s_waitcnt lgkmcnt(5)
    v_mfma_f32_16x16x32_bf16 v[80:83], v[32:35], v[164:167], v[80:83]
    s_waitcnt vmcnt(14)
    s_mov_b64 exec, 0xff
    buffer_store_dwordx4 v[2:5], v1, s[48:51], s18 offen offset:128 sc1
    s_mov_b64 exec, -1
    v_mfma_f32_16x16x32_bf16 v[84:87], v[32:35], v[172:175], v[84:87]
    ds_read_b128 v[44:47], v17 offset:1088
    v_lshl_or_b32 v21, v21, 1, v3
    v_mfma_f32_16x16x32_bf16 v[88:91], v[32:35], v[180:183], v[88:91]
    ds_read_b64_tr_b16 a[46:47], v9 offset:35840
    v_bfe_u32 v26, v0, 1, 1
    v_mfma_f32_16x16x32_bf16 v[92:95], v[32:35], v[188:191], v[92:95]
    ds_read_b64 v[48:49], v16 offset:3136
    v_lshlrev_b32 v26, 3, v26
    v_mfma_f32_16x16x32_bf16 v[80:83], v[160:163], v[36:39], v[80:83]
    ds_read_b64 v[50:51], v16 offset:3144
    v_xor_b32_e64 v21, v21, v26
    v_mfma_f32_16x16x32_bf16 v[84:87], v[168:171], v[36:39], v[84:87]
    ds_read_b128 v[52:55], v17 offset:576
    v_bfe_u32 v27, v0, 1, 2
    v_mfma_f32_16x16x32_bf16 v[88:91], v[176:179], v[36:39], v[88:91]
    ds_read_b64 v[56:57], v16 offset:3648
    v_lshl_add_u32 v21, v27, 4, v21
    v_mfma_f32_16x16x32_bf16 v[92:95], v[184:187], v[36:39], v[92:95]
    ds_read_b64 v[58:59], v16 offset:3656
    s_waitcnt lgkmcnt(6)
    v_mfma_f32_16x16x32_bf16 v[84:87], v[40:43], v[164:167], v[84:87]
    ds_read_b128 v[60:63], v17 offset:64
    s_lshl_b32 s61, s56, 11
    v_mfma_f32_16x16x32_bf16 v[88:91], v[40:43], v[172:175], v[88:91]
    ds_read_b64 v[96:97], v16 offset:128
    s_add_u32 s61, s61, 49152
    v_mfma_f32_16x16x32_bf16 v[92:95], v[40:43], v[180:183], v[92:95]
    ds_read_b64 v[98:99], v16 offset:136
    v_lshl_add_u32 v21, v21, 4, s61
    v_mfma_f32_16x16x32_bf16 v[84:87], v[160:163], v[44:47], v[84:87]
    ds_read_b128 v[100:103], v17 offset:3712
    s_add_u32 s61, s73, 98304
    v_mfma_f32_16x16x32_bf16 v[88:91], v[168:171], v[44:47], v[88:91]
    ds_read_b64 v[104:105], v16 offset:640
    v_add_u32_e64 v4, s61, v1
    v_mfma_f32_16x16x32_bf16 v[92:95], v[176:179], v[44:47], v[92:95]
    ds_read_b64 v[106:107], v16 offset:648
    s_waitcnt lgkmcnt(8)
    v_mfma_f32_16x16x32_bf16 v[88:91], v[48:51], v[164:167], v[88:91]
    ds_read_b128 v[108:111], v17 offset:3200
    v_xor_b32 v5, 4096, v4
    v_mfma_f32_16x16x32_bf16 v[92:95], v[48:51], v[172:175], v[92:95]
    ds_read_b64 v[112:113], v16 offset:1152
    v_lshl_or_b32 v27, v3, 2, v27
    v_mfma_f32_16x16x32_bf16 v[88:91], v[160:163], v[52:55], v[88:91]
    ds_read_b64 v[114:115], v16 offset:1160
    v_and_or_b32 v27, v0, 24, v27
    v_mfma_f32_16x16x32_bf16 v[92:95], v[168:171], v[52:55], v[92:95]
    ds_read_b128 v[116:119], v17 offset:2688
    s_waitcnt lgkmcnt(9)
    v_mfma_f32_16x16x32_bf16 v[92:95], v[56:59], v[164:167], v[92:95]
    ds_read_b64_tr_b16 a[48:49], v8 offset:40960
    v_lshrrev_b32_e64 v3, 5, v0
    v_mfma_f32_16x16x32_bf16 v[92:95], v[160:163], v[60:63], v[92:95]
    ds_read_b64_tr_b16 a[50:51], v8 offset:41984
    s_waitcnt lgkmcnt(8)
    v_mfma_f32_16x16x32_bf16 v[64:67], v[96:99], v[100:103], v[64:67]
    ds_read_b64 v[120:121], v16 offset:1664
    s_waitcnt lgkmcnt(6)
    v_mfma_f32_16x16x32_bf16 v[68:71], v[104:107], v[100:103], v[68:71]
    ds_read_b64 v[122:123], v16 offset:1672
    v_lshl_or_b32 v27, v3, 6, v27
    v_mfma_f32_16x16x32_bf16 v[68:71], v[96:99], v[108:111], v[68:71]
    ds_read_b128 v[124:127], v17 offset:2176
    s_add_u32 s91, s73, 32768
    v_mfma_f32_16x16x32_bf16 v[72:75], v[104:107], v[108:111], v[72:75]
    ds_read_b64_tr_b16 a[52:53], v9 offset:40960
    s_waitcnt lgkmcnt(6)
    v_mfma_f32_16x16x32_bf16 v[72:75], v[112:115], v[100:103], v[72:75]
    ds_read_b64_tr_b16 a[54:55], v9 offset:41984
    v_lshl_add_u32 v22, v27, 2, s91
    v_mfma_f32_16x16x32_bf16 v[76:79], v[112:115], v[108:111], v[76:79]
    ds_read_b64 v[128:129], v16 offset:2176
    v_add_u32 v25, 1024, v22
    v_mfma_f32_16x16x32_bf16 v[72:75], v[96:99], v[116:119], v[72:75]
    ds_read_b64 v[130:131], v16 offset:2184
    s_lshl_b32 s63, s95, 6
    v_mfma_f32_16x16x32_bf16 v[76:79], v[104:107], v[116:119], v[76:79]
    ds_read_b128 v[132:135], v17 offset:1664
    s_add_u32 s61, s63, 90112
    v_mfma_f32_16x16x32_bf16 v[80:83], v[112:115], v[116:119], v[80:83]
    ds_read_b64 v[136:137], v16 offset:2688
    s_waitcnt lgkmcnt(6)
    v_mfma_f32_16x16x32_bf16 v[76:79], v[120:123], v[100:103], v[76:79]
    ds_read_b64 v[138:139], v16 offset:2696
    v_lshl_add_u32 v24, v3, 3, s61
    v_mfma_f32_16x16x32_bf16 v[80:83], v[120:123], v[108:111], v[80:83]
    ds_read_b128 v[140:143], v17 offset:1152
    s_lshl1_add_u32 s62, s83, s57
    v_mfma_f32_16x16x32_bf16 v[84:87], v[120:123], v[116:119], v[84:87]
    s_waitcnt vmcnt(3)
    v_cmp_ne_u32 vcc, v19, v2
    s_nop 0
    s_and_b64 vcc, vcc, 0xff7f
    s_cbranch_vccnz SLOW_FH0
BACK_FH0:
    v_mfma_f32_16x16x32_bf16 v[76:79], v[96:99], v[124:127], v[76:79]
    s_cmp_eq_u32 s60, 0
    s_cbranch_scc1 SVC_OL0
SVB_OL0:
    s_lshl_b32 s61, s62, 8
    v_mfma_f32_16x16x32_bf16 v[80:83], v[104:107], v[124:127], v[80:83]
    s_add_u32 s93, s85, s75
    buffer_load_dwordx4 v[192:195], v1, s[48:51], s93 offen offset:0 sc1
    v_mfma_f32_16x16x32_bf16 v[84:87], v[112:115], v[124:127], v[84:87]
    ds_read_b64 v[144:145], v16 offset:3200
    s_add_u32 s61, s61, s82
    v_mfma_f32_16x16x32_bf16 v[88:91], v[120:123], v[124:127], v[88:91]
    ds_read_b64 v[146:147], v16 offset:3208
    s_waitcnt lgkmcnt(5)
    v_mfma_f32_16x16x32_bf16 v[80:83], v[128:131], v[100:103], v[80:83]
    ds_read_b128 v[148:151], v17 offset:640
    s_lshl_b32 s61, s61, 7
    v_mfma_f32_16x16x32_bf16 v[84:87], v[128:131], v[108:111], v[84:87]
    buffer_load_dwordx4 v[196:199], v1, s[48:51], s93 offen offset:1024 sc1
    v_mfma_f32_16x16x32_bf16 v[88:91], v[128:131], v[116:119], v[88:91]
    ds_read_b64 v[152:153], v16 offset:3712
    s_add_u32 s61, s61, s63
    v_mfma_f32_16x16x32_bf16 v[92:95], v[128:131], v[124:127], v[92:95]
    ds_read_b64 v[154:155], v16 offset:3720
    v_lshl_add_u32 v23, v3, 4, s61
    v_mfma_f32_16x16x32_bf16 v[80:83], v[96:99], v[132:135], v[80:83]
    ds_read_b128 v[156:159], v17 offset:128
    v_and_b32_e64 v26, 15, v0
    v_mfma_f32_16x16x32_bf16 v[84:87], v[104:107], v[132:135], v[84:87]
    buffer_load_dwordx4 v[200:203], v1, s[48:51], s93 offen offset:2048 sc1
    v_mfma_f32_16x16x32_bf16 v[88:91], v[112:115], v[132:135], v[88:91]
    ds_read_b64 v[160:161], v16 offset:192
    v_lshl_add_u32 v23, v26, 10, v23
    v_mfma_f32_16x16x32_bf16 v[92:95], v[120:123], v[132:135], v[92:95]
    ds_read_b64 v[162:163], v16 offset:200
    s_waitcnt lgkmcnt(8)
    v_mfma_f32_16x16x32_bf16 v[84:87], v[136:139], v[100:103], v[84:87]
    ds_read_b128 v[164:167], v17 offset:3776
    v_and_b32 v26, 16, v0
    v_mfma_f32_16x16x32_bf16 v[88:91], v[136:139], v[108:111], v[88:91]
    buffer_load_dwordx4 v[204:207], v1, s[48:51], s93 offen offset:3072 sc1
    v_mfma_f32_16x16x32_bf16 v[92:95], v[136:139], v[116:119], v[92:95]
    ds_read_b64 v[168:169], v16 offset:704
    v_lshl_add_u32 v23, v26, 1, v23
    v_mfma_f32_16x16x32_bf16 v[84:87], v[96:99], v[140:143], v[84:87]
    ds_read_b64 v[170:171], v16 offset:712
    s_movk_i32 s89, 16384
    v_mfma_f32_16x16x32_bf16 v[88:91], v[104:107], v[140:143], v[88:91]
    ds_read_b128 v[172:175], v17 offset:3264
    v_lshrrev_b32 v27, 3, v0
    v_mfma_f32_16x16x32_bf16 v[92:95], v[112:115], v[140:143], v[92:95]
    s_add_u32 s93, s85, s76
    buffer_load_dwordx4 v[208:211], v1, s[48:51], s93 offen offset:0 sc1
    s_waitcnt lgkmcnt(9)
    v_mfma_f32_16x16x32_bf16 v[88:91], v[144:147], v[100:103], v[88:91]
    ds_read_b64 v[176:177], v16 offset:1216
    v_and_b32 v26, 0x70, v1
    v_mfma_f32_16x16x32_bf16 v[92:95], v[144:147], v[108:111], v[92:95]
    ds_read_b64 v[178:179], v16 offset:1224
    v_lshl_add_u32 v27, v27, 13, v26
    v_mfma_f32_16x16x32_bf16 v[88:91], v[96:99], v[148:151], v[88:91]
    ds_read_b128 v[180:183], v17 offset:2752
    s_lshl1_add_u32 s92, s82, s95
    v_mfma_f32_16x16x32_bf16 v[92:95], v[104:107], v[148:151], v[92:95]
    buffer_load_dwordx4 v[212:215], v1, s[48:51], s93 offen offset:1024 sc1
    s_waitcnt lgkmcnt(9)
    v_mfma_f32_16x16x32_bf16 v[92:95], v[152:155], v[100:103], v[92:95]
    ds_read_b64_tr_b16 a[56:57], v8 offset:43008
    s_lshl_b32 s92, s92, 10
    v_mfma_f32_16x16x32_bf16 v[92:95], v[96:99], v[156:159], v[92:95]
    ds_read_b64 v[184:185], v16 offset:1728
    s_waitcnt lgkmcnt(8)
    v_mfma_f32_16x16x32_bf16 v[64:67], v[160:163], v[164:167], v[64:67]
    ds_read_b64 v[186:187], v16 offset:1736
    s_waitcnt lgkmcnt(6)
    v_mfma_f32_16x16x32_bf16 v[68:71], v[168:171], v[164:167], v[68:71]
    buffer_load_dwordx4 v[216:219], v1, s[48:51], s93 offen offset:2048 sc1
    v_mfma_f32_16x16x32_bf16 v[68:71], v[160:163], v[172:175], v[68:71]
    ds_read_b128 v[188:191], v17 offset:2240
    s_add_u32 s92, s92, s62
    v_mfma_f32_16x16x32_bf16 v[72:75], v[168:171], v[172:175], v[72:75]
    ds_read_b64_tr_b16 a[58:59], v8 offset:44032
    s_waitcnt lgkmcnt(5)
    v_mfma_f32_16x16x32_bf16 v[72:75], v[176:179], v[164:167], v[72:75]
    ds_read_b64_tr_b16 a[60:61], v9 offset:43008
    s_lshl_b32 s92, s92, 7
    v_mfma_f32_16x16x32_bf16 v[76:79], v[176:179], v[172:175], v[76:79]
    buffer_load_dwordx4 v[220:223], v1, s[48:51], s93 offen offset:3072 sc1
    v_mfma_f32_16x16x32_bf16 v[72:75], v[160:163], v[180:183], v[72:75]
    ds_read_b64 v[32:33], v16 offset:2240
    s_add_u32 s92, s92, 10485760
    v_mfma_f32_16x16x32_bf16 v[76:79], v[168:171], v[180:183], v[76:79]
    ds_read_b64 v[34:35], v16 offset:2248
    s_add_u32 s90, s92, 64512
    v_mfma_f32_16x16x32_bf16 v[80:83], v[176:179], v[180:183], v[80:83]
    ds_read_b128 v[36:39], v17 offset:1728
    s_waitcnt lgkmcnt(5)
    v_mfma_f32_16x16x32_bf16 v[76:79], v[184:187], v[164:167], v[76:79]
    s_add_u32 s93, s85, s77
    buffer_load_dwordx4 a[224:227], v1, s[48:51], s93 offen offset:0 sc1
    v_mfma_f32_16x16x32_bf16 v[80:83], v[184:187], v[172:175], v[80:83]
    ds_read_b64_tr_b16 a[62:63], v9 offset:44032
    s_lshl_b32 s84, s81, 1
    v_mfma_f32_16x16x32_bf16 v[84:87], v[184:187], v[180:183], v[84:87]
    ds_read_b64_tr_b16 a[64:65], v10 offset:16384
    s_xor_b32 s19, s84, 16384
    v_mfma_f32_16x16x32_bf16 v[76:79], v[160:163], v[188:191], v[76:79]
    ds_read_b64_tr_b16 a[66:67], v10 offset:17408
    v_mfma_f32_16x16x32_bf16 v[80:83], v[168:171], v[188:191], v[80:83]
    buffer_load_dwordx4 a[228:231], v1, s[48:51], s93 offen offset:1024 sc1
    v_mfma_f32_16x16x32_bf16 v[84:87], v[176:179], v[188:191], v[84:87]
    ds_read_b64 v[40:41], v16 offset:2752
    v_mfma_f32_16x16x32_bf16 v[88:91], v[184:187], v[188:191], v[88:91]
    ds_read_b64 v[42:43], v16 offset:2760
    s_waitcnt lgkmcnt(5)
    v_mfma_f32_16x16x32_bf16 v[80:83], v[32:35], v[164:167], v[80:83]
    ds_read_b128 v[44:47], v17 offset:1216
    v_mfma_f32_16x16x32_bf16 v[84:87], v[32:35], v[172:175], v[84:87]
    buffer_load_dwordx4 a[232:235], v1, s[48:51], s93 offen offset:2048 sc1
    v_mfma_f32_16x16x32_bf16 v[88:91], v[32:35], v[180:183], v[88:91]
    ds_read_b64_tr_b16 a[68:69], v11 offset:16384
    v_mfma_f32_16x16x32_bf16 v[92:95], v[32:35], v[188:191], v[92:95]
    ds_read_b64 v[48:49], v16 offset:3264
    v_mfma_f32_16x16x32_bf16 v[80:83], v[160:163], v[36:39], v[80:83]
    ds_read_b64 v[50:51], v16 offset:3272
    v_cndmask_b32 v18, -1, v18, s[14:15]
    v_mfma_f32_16x16x32_bf16 v[84:87], v[168:171], v[36:39], v[84:87]
    buffer_load_dwordx4 a[236:239], v1, s[48:51], s93 offen offset:3072 sc1
    v_mfma_f32_16x16x32_bf16 v[88:91], v[176:179], v[36:39], v[88:91]
    buffer_load_dword v19, v18, s[48:51], 0 offen offset:128 sc1
    v_mfma_f32_16x16x32_bf16 v[92:95], v[184:187], v[36:39], v[92:95]
    ds_read_b128 v[52:55], v17 offset:704
    s_waitcnt lgkmcnt(4)
    v_mfma_f32_16x16x32_bf16 v[84:87], v[40:43], v[164:167], v[84:87]
    ds_read_b64 v[56:57], v16 offset:3776
    v_mfma_f32_16x16x32_bf16 v[88:91], v[40:43], v[172:175], v[88:91]
    s_add_u32 s93, s85, s78
    buffer_load_dwordx4 a[240:243], v1, s[48:51], s93 offen offset:0 sc1
    v_mfma_f32_16x16x32_bf16 v[92:95], v[40:43], v[180:183], v[92:95]
    ds_read_b64 v[58:59], v16 offset:3784
    v_mfma_f32_16x16x32_bf16 v[84:87], v[160:163], v[44:47], v[84:87]
    ds_read_b128 v[60:63], v17 offset:192
    v_mfma_f32_16x16x32_bf16 v[88:91], v[168:171], v[44:47], v[88:91]
    ds_read_b64_tr_b16 a[70:71], v11 offset:17408
    ds_read_b64_tr_b16 a[72:73], v10 offset:18432
    ds_read_b64_tr_b16 a[74:75], v10 offset:19456
    ds_read_b64_tr_b16 a[76:77], v11 offset:18432
    ds_read_b64_tr_b16 a[78:79], v11 offset:19456
    ds_read_b64_tr_b16 a[80:81], v10 offset:24576
    ds_read_b64_tr_b16 a[82:83], v10 offset:25600
    ds_read_b64_tr_b16 a[84:85], v11 offset:24576
    ds_read_b64_tr_b16 a[86:87], v11 offset:25600
    ds_read_b64_tr_b16 a[88:89], v10 offset:26624
    ds_read_b64_tr_b16 a[90:91], v10 offset:27648
    ds_read_b64_tr_b16 a[92:93], v11 offset:26624
    ds_read_b64_tr_b16 a[94:95], v11 offset:27648
    v_mfma_f32_16x16x32_bf16 v[92:95], v[176:179], v[44:47], v[92:95]
    buffer_load_dwordx4 a[244:247], v1, s[48:51], s93 offen offset:1024 sc1
    s_waitcnt lgkmcnt(14)
    v_mfma_f32_16x16x32_bf16 v[88:91], v[48:51], v[164:167], v[88:91]
    v_mfma_f32_16x16x32_bf16 v[92:95], v[48:51], v[172:175], v[92:95]
    v_mfma_f32_16x16x32_bf16 v[88:91], v[160:163], v[52:55], v[88:91]
    v_mfma_f32_16x16x32_bf16 v[92:95], v[168:171], v[52:55], v[92:95]
    s_waitcnt vmcnt(16) lgkmcnt(0)
    s_barrier
    v_mfma_f32_16x16x32_bf16 v[92:95], v[56:59], v[164:167], v[92:95]
    v_mfma_f32_16x16x32_bf16 v[92:95], v[160:163], v[60:63], v[92:95]
    ds_write_b128 v20, v[64:67] offset:0
    ds_write_b128 v20, v[68:71] offset:1024
    buffer_load_dwordx4 a[248:251], v1, s[48:51], s93 offen offset:2048 sc1
    ds_write_b128 v20, v[72:75] offset:2048
    buffer_load_dwordx4 a[252:255], v1, s[48:51], s93 offen offset:3072 sc1
    ds_write_b128 v20, v[76:79] offset:3072
    s_add_u32 s93, s85, s79
    buffer_load_dwordx4 v[136:139], v1, s[48:51], s93 offen offset:0 sc1
    ds_write_b128 v20, v[80:83] offset:4096
    ds_write_b128 v20, v[84:87] offset:5120
    buffer_load_dwordx4 v[140:143], v1, s[48:51], s93 offen offset:1024 sc1
    ds_write_b128 v20, v[88:91] offset:6144
    buffer_load_dwordx4 v[144:147], v1, s[48:51], s93 offen offset:2048 sc1
    ds_write_b128 v20, v[92:95] offset:7168
    buffer_load_dwordx4 v[148:151], v1, s[48:51], s93 offen offset:3072 sc1
    s_waitcnt lgkmcnt(0)
    s_barrier
    s_cmp_eq_u32 s60, 0
    s_cbranch_scc1 SVC_OW0
SVB_OW0:
    v_mfma_f32_32x32x16_bf16 v[32:47], a[0:3], v[224:227], 0
    s_add_u32 s93, s85, s80
    buffer_load_dwordx4 v[180:183], v1, s[48:51], s93 offen offset:0 sc1
    v_mov_b32 v171, v2
    v_mfma_f32_32x32x16_bf16 v[48:63], a[4:7], v[224:227], 0
    ds_read_b128 v[96:99], v21 offset:0
    ds_read_b128 v[100:103], v21 offset:1024
    ds_read_b128 v[104:107], v21 offset:8192
    v_mfma_f32_32x32x16_bf16 v[32:47], a[8:11], v[228:231], v[32:47]
    buffer_load_dwordx4 v[184:187], v1, s[48:51], s93 offen offset:1024 sc1
    ds_read_b128 v[108:111], v21 offset:9216
    v_mfma_f32_32x32x16_bf16 v[48:63], a[12:15], v[228:231], v[48:63]
    ds_read_b128 v[112:115], v21 offset:16384
    ds_read_b128 v[116:119], v21 offset:17408
    ds_read_b128 v[120:123], v21 offset:24576
    v_mfma_f32_32x32x16_bf16 v[32:47], a[16:19], v[232:235], v[32:47]
    buffer_load_dwordx4 v[188:191], v1, s[48:51], s93 offen offset:2048 sc1
    ds_read_b128 v[124:127], v21 offset:25600
    v_mfma_f32_32x32x16_bf16 v[48:63], a[20:23], v[232:235], v[48:63]
    s_waitcnt vmcnt(11)
    v_cmp_ne_u32 vcc, v19, v2
    s_nop 0
    s_and_b64 vcc, vcc, 0x7f
    s_cbranch_vccnz SLOW_FH1
BACK_FH1:
    v_mov_b32 v175, v2
    v_mov_b32 v179, v2
    v_mfma_f32_32x32x16_bf16 v[32:47], a[24:27], v[236:239], v[32:47]
    buffer_load_dwordx4 v[152:155], v1, s[48:51], s93 offen offset:3072 sc1
    s_waitcnt lgkmcnt(4)
    v_add_f32 v96, v96, v104
    v_mfma_f32_32x32x16_bf16 v[48:63], a[28:31], v[236:239], v[48:63]
    s_cmp_eq_u32 s60, 0
    s_cbranch_scc1 SVC_OL1
SVB_OL1:
    v_add_f32 v97, v97, v105
    v_add_f32 v98, v98, v106
    v_add_f32 v99, v99, v107
    v_add_f32 v100, v100, v108
    v_mfma_f32_32x32x16_bf16 v[32:47], a[32:35], v[192:195], v[32:47]
    s_add_u32 s93, s86, s75
    buffer_load_dwordx4 v[156:159], v1, s[48:51], s93 offen offset:0 sc1
    v_add_f32 v101, v101, v109
    v_mfma_f32_32x32x16_bf16 v[48:63], a[36:39], v[192:195], v[48:63]
    v_add_f32 v102, v102, v110
    v_add_f32 v103, v103, v111
    s_waitcnt lgkmcnt(0)
    v_add_f32 v112, v112, v120
    v_add_f32_e64 v113, v113, v121
    v_mfma_f32_32x32x16_bf16 v[32:47], a[40:43], v[196:199], v[32:47]
    buffer_load_dwordx4 v[192:195], v1, s[48:51], s93 offen offset:1024 sc1
    v_add_f32 v114, v114, v122
    v_add_f32 v115, v115, v123
    v_mfma_f32_32x32x16_bf16 v[48:63], a[44:47], v[196:199], v[48:63]
    ds_read_b64_tr_b16 a[96:97], v8 offset:0
    v_cvt_pk_bf16_f32 v104, v96, v112
    v_cvt_pk_bf16_f32 v105, v97, v113
    v_cvt_pk_bf16_f32 v106, v98, v114
    v_cvt_pk_bf16_f32 v107, v99, v115
    v_mfma_f32_32x32x16_bf16 v[32:47], a[48:51], v[200:203], v[32:47]
    ds_read_b64_tr_b16 a[98:99], v8 offset:1024
    buffer_load_dwordx4 v[196:199], v1, s[48:51], s93 offen offset:2048 sc1
    v_mfma_f32_32x32x16_bf16 v[48:63], a[52:55], v[200:203], v[48:63]
    ds_read_b64_tr_b16 a[104:105], v8 offset:2048
    ds_read_b64_tr_b16 a[106:107], v8 offset:3072
    ds_read_b64_tr_b16 a[100:101], v9 offset:0
    v_mfma_f32_32x32x16_bf16 v[32:47], a[56:59], v[204:207], v[32:47]
    ds_read_b64_tr_b16 a[102:103], v9 offset:1024
    buffer_store_dwordx4 v[104:107], v1, s[48:51], s81 offen offset:0 sc1
    v_mfma_f32_32x32x16_bf16 v[48:63], a[60:63], v[204:207], v[48:63]
    ds_read_b64_tr_b16 a[108:109], v9 offset:2048
    v_add_f32 v116, v116, v124
    v_add_f32 v117, v117, v125
    v_add_f32 v118, v118, v126
    v_add_f32 v119, v119, v127
    v_cvt_pk_bf16_f32 v108, v100, v116
    v_mfma_f32_32x32x16_bf16 v[32:47], a[64:67], v[208:211], v[32:47]
    buffer_load_dwordx4 v[200:203], v1, s[48:51], s93 offen offset:3072 sc1
    v_cvt_pk_bf16_f32 v109, v101, v117
    v_cvt_pk_bf16_f32 v110, v102, v118
    v_mfma_f32_32x32x16_bf16 v[48:63], a[68:71], v[208:211], v[48:63]
    ds_read_b64_tr_b16 a[110:111], v9 offset:3072
    ds_read_b64_tr_b16 a[112:113], v8 offset:8192
    ds_read_b64_tr_b16 a[114:115], v8 offset:9216
    v_cvt_pk_bf16_f32 v111, v103, v119
    v_mfma_f32_32x32x16_bf16 v[32:47], a[72:75], v[212:215], v[32:47]
    ds_read_b64_tr_b16 a[120:121], v8 offset:10240
    buffer_store_dwordx4 v[108:111], v1, s[48:51], s81 offen offset:1024 sc1
    v_mfma_f32_32x32x16_bf16 v[48:63], a[76:79], v[212:215], v[48:63]
    ds_read_b64_tr_b16 a[122:123], v8 offset:11264
    ds_read_b64_tr_b16 a[128:129], v10 offset:32768
    ds_read_b64_tr_b16 a[130:131], v10 offset:33792
    v_mfma_f32_32x32x16_bf16 v[32:47], a[80:83], v[216:219], v[32:47]
    ds_read_b64_tr_b16 a[136:137], v10 offset:34816
    s_add_u32 s93, s86, s76
    buffer_load_dwordx4 v[204:207], v1, s[48:51], s93 offen offset:0 sc1
    v_mfma_f32_32x32x16_bf16 v[48:63], a[84:87], v[216:219], v[48:63]
    ds_read_b64_tr_b16 a[138:139], v10 offset:35840
    ds_read_b64_tr_b16 a[144:145], v10 offset:40960
    ds_read_b64_tr_b16 a[146:147], v10 offset:41984
    v_mfma_f32_32x32x16_bf16 v[32:47], a[88:91], v[220:223], v[32:47]
    ds_read_b64_tr_b16 a[152:153], v10 offset:43008
    buffer_load_dwordx4 v[208:211], v1, s[48:51], s93 offen offset:1024 sc1
    v_mfma_f32_32x32x16_bf16 v[48:63], a[92:95], v[220:223], v[48:63]
    ds_read_b64_tr_b16 a[154:155], v10 offset:44032
    ds_read_b64_tr_b16 a[160:161], v8 offset:16384
    ds_read_b64_tr_b16 a[162:163], v8 offset:17408
    s_waitcnt lgkmcnt(14)
    v_mfma_f32_32x32x16_bf16 v[32:47], a[96:99], a[224:227], v[32:47]
    ds_read_b64_tr_b16 a[168:169], v8 offset:18432
    buffer_load_dwordx4 v[212:215], v1, s[48:51], s93 offen offset:2048 sc1
    v_mfma_f32_32x32x16_bf16 v[48:63], a[100:103], a[224:227], v[48:63]
    ds_read_b64_tr_b16 a[170:171], v8 offset:19456
    ds_read_b64_tr_b16 a[176:177], v8 offset:24576
    ds_read_b64_tr_b16 a[178:179], v8 offset:25600
    v_mfma_f32_32x32x16_bf16 v[32:47], a[104:107], a[228:231], v[32:47]
    ds_read_b64_tr_b16 a[184:185], v8 offset:26624
    buffer_load_dwordx4 v[216:219], v1, s[48:51], s93 offen offset:3072 sc1
    v_mfma_f32_32x32x16_bf16 v[48:63], a[108:111], a[228:231], v[48:63]
    ds_read_b64_tr_b16 a[186:187], v8 offset:27648
    ds_read_b64_tr_b16 a[192:193], v10 offset:49152
    ds_read_b64_tr_b16 a[194:195], v10 offset:50176
    s_waitcnt lgkmcnt(14)
    v_mfma_f32_32x32x16_bf16 v[32:47], a[112:115], a[232:235], v[32:47]
    s_add_u32 s93, s86, s77
    buffer_load_dwordx4 v[220:223], v1, s[48:51], s93 offen offset:0 sc1
    v_mfma_f32_32x32x16_bf16 v[32:47], a[120:123], a[236:239], v[32:47]
    ds_read_b64_tr_b16 a[200:201], v10 offset:51200
    ds_read_b64_tr_b16 a[202:203], v10 offset:52224
    ds_read_b64_tr_b16 a[208:209], v10 offset:57344
    s_waitcnt vmcnt(22)
    v_mfma_f32_32x32x16_bf16 v[32:47], a[128:131], a[240:243], v[32:47]
    ds_read_b64_tr_b16 a[210:211], v10 offset:58368
    buffer_load_dwordx4 a[224:227], v1, s[48:51], s93 offen offset:1024 sc1
    s_waitcnt vmcnt(22)
    v_mfma_f32_32x32x16_bf16 v[32:47], a[136:139], a[244:247], v[32:47]
    ds_read_b64_tr_b16 a[216:217], v10 offset:59392
    ds_read_b64_tr_b16 a[218:219], v10 offset:60416
    ds_read_b64_tr_b16 a[116:117], v9 offset:8192
    s_waitcnt vmcnt(21) lgkmcnt(14)
    v_mfma_f32_32x32x16_bf16 v[32:47], a[144:147], a[248:251], v[32:47]
    ds_read_b64_tr_b16 a[118:119], v9 offset:9216
    buffer_load_dwordx4 a[228:231], v1, s[48:51], s93 offen offset:2048 sc1
    s_waitcnt vmcnt(21)
    v_mfma_f32_32x32x16_bf16 v[32:47], a[152:155], a[252:255], v[32:47]
    ds_read_b64_tr_b16 a[124:125], v9 offset:10240
    ds_read_b64_tr_b16 a[126:127], v9 offset:11264
    ds_read_b64_tr_b16 a[132:133], v11 offset:32768
    s_waitcnt vmcnt(20) lgkmcnt(14)
    v_mfma_f32_32x32x16_bf16 v[32:47], a[160:163], v[136:139], v[32:47]
    ds_read_b64_tr_b16 a[134:135], v11 offset:33792
    buffer_load_dwordx4 v[160:163], v1, s[48:51], s93 offen offset:3072 sc1
    s_waitcnt vmcnt(20)
    v_mfma_f32_32x32x16_bf16 v[32:47], a[168:171], v[140:143], v[32:47]
    ds_read_b64_tr_b16 a[140:141], v11 offset:34816
    ds_read_b64_tr_b16 a[142:143], v11 offset:35840
    ds_read_b64_tr_b16 a[148:149], v11 offset:40960
    s_waitcnt vmcnt(19) lgkmcnt(14)
    v_mfma_f32_32x32x16_bf16 v[32:47], a[176:179], v[144:147], v[32:47]
    s_add_u32 s93, s86, s78
    buffer_load_dwordx4 v[164:167], v1, s[48:51], s93 offen offset:0 sc1
    s_waitcnt vmcnt(19)
    v_mfma_f32_32x32x16_bf16 v[32:47], a[184:187], v[148:151], v[32:47]
    ds_read_b64_tr_b16 a[150:151], v11 offset:41984
    ds_read_b64_tr_b16 a[156:157], v11 offset:43008
    ds_read_b64_tr_b16 a[158:159], v11 offset:44032
    s_waitcnt vmcnt(18) lgkmcnt(14)
    v_mfma_f32_32x32x16_bf16 v[32:47], a[192:195], v[180:183], v[32:47]
    ds_read_b64_tr_b16 a[164:165], v9 offset:16384
    buffer_load_dwordx4 v[224:227], v1, s[48:51], s93 offen offset:1024 sc1
    s_waitcnt vmcnt(18)
    v_mfma_f32_32x32x16_bf16 v[32:47], a[200:203], v[184:187], v[32:47]
    ds_read_b64_tr_b16 a[166:167], v9 offset:17408
    ds_read_b64_tr_b16 a[172:173], v9 offset:18432
    ds_read_b64_tr_b16 a[174:175], v9 offset:19456
    s_waitcnt vmcnt(17) lgkmcnt(14)
    v_mfma_f32_32x32x16_bf16 v[32:47], a[208:211], v[188:191], v[32:47]
    ds_read_b64_tr_b16 a[180:181], v9 offset:24576
    buffer_load_dwordx4 v[228:231], v1, s[48:51], s93 offen offset:2048 sc1
    s_waitcnt vmcnt(17)
    v_mfma_f32_32x32x16_bf16 v[32:47], a[216:219], v[152:155], v[32:47]
    ds_read_b64_tr_b16 a[182:183], v9 offset:25600
    ds_read_b64_tr_b16 a[188:189], v9 offset:26624
    ds_read_b64_tr_b16 a[190:191], v9 offset:27648
    s_waitcnt lgkmcnt(14)
    v_mfma_f32_32x32x16_bf16 v[48:63], a[116:119], a[232:235], v[48:63]
    ds_read_b64_tr_b16 a[196:197], v11 offset:49152
    buffer_load_dwordx4 v[232:235], v1, s[48:51], s93 offen offset:3072 sc1
    v_mfma_f32_32x32x16_bf16 v[48:63], a[124:127], a[236:239], v[48:63]
    ds_read_b64_tr_b16 a[198:199], v11 offset:50176
    ds_read_b64_tr_b16 a[204:205], v11 offset:51200
    ds_read_b64_tr_b16 a[206:207], v11 offset:52224
    s_waitcnt lgkmcnt(14)
    v_mfma_f32_32x32x16_bf16 v[48:63], a[132:135], a[240:243], v[48:63]
    ds_read_b64_tr_b16 a[212:213], v11 offset:57344
    s_add_u32 s93, s86, s79
    buffer_load_dwordx4 a[232:235], v1, s[48:51], s93 offen offset:0 sc1
    v_mfma_f32_32x32x16_bf16 v[48:63], a[140:143], a[244:247], v[48:63]
    ds_write_b128 v4, v[32:35] offset:0
    s_waitcnt lgkmcnt(14)
    v_mfma_f32_32x32x16_bf16 v[48:63], a[148:151], a[248:251], v[48:63]
    ds_read_b64_tr_b16 a[214:215], v11 offset:58368
    buffer_load_dwordx4 a[236:239], v1, s[48:51], s93 offen offset:1024 sc1
IW3:
    s_cbranch_execz IWBACK
    s_nop 0
    v_mfma_f32_32x32x16_bf16 v[48:63], a[156:159], a[252:255], v[48:63]
    ds_write_b128 v4, v[36:39] offset:1024
    s_waitcnt lgkmcnt(12)
    v_mfma_f32_32x32x16_bf16 v[48:63], a[164:167], v[136:139], v[48:63]
    ds_read_b64_tr_b16 a[220:221], v11 offset:59392
    buffer_load_dwordx4 a[240:243], v1, s[48:51], s93 offen offset:2048 sc1
    v_mfma_f32_32x32x16_bf16 v[48:63], a[172:175], v[140:143], v[48:63]
    ds_write_b128 v4, v[40:43] offset:2048
    s_waitcnt lgkmcnt(10)
    v_mfma_f32_32x32x16_bf16 v[48:63], a[180:183], v[144:147], v[48:63]
    ds_read_b64_tr_b16 a[222:223], v11 offset:60416
    buffer_load_dwordx4 a[244:247], v1, s[48:51], s93 offen offset:3072 sc1
    v_mfma_f32_32x32x16_bf16 v[48:63], a[188:191], v[148:151], v[48:63]
    ds_write_b128 v4, v[44:47] offset:3072
    s_waitcnt lgkmcnt(8)
    v_mfma_f32_32x32x16_bf16 v[48:63], a[196:199], v[180:183], v[48:63]
    s_add_u32 s93, s86, s80
    buffer_load_dwordx4 a[248:251], v1, s[48:51], s93 offen offset:0 sc1
    v_mfma_f32_32x32x16_bf16 v[48:63], a[204:207], v[184:187], v[48:63]
    s_waitcnt lgkmcnt(0)
    s_barrier
    ds_read_b128 v[96:99], v5 offset:0
    ds_read_b128 v[100:103], v5 offset:1024
    v_mfma_f32_32x32x16_bf16 v[48:63], a[212:215], v[188:191], v[48:63]
    buffer_load_dwordx4 a[252:255], v1, s[48:51], s93 offen offset:1024 sc1
    ds_read_b128 v[104:107], v5 offset:2048
    v_mfma_f32_32x32x16_bf16 v[48:63], a[220:223], v[152:155], v[48:63]
    ds_read_b128 v[108:111], v5 offset:3072
    s_cmp_eq_u32 s60, 0
    s_cbranch_scc1 SVC_OW1
SVB_OW1:
    v_mfma_f32_32x32x16_bf16 v[64:79], a[0:3], v[240:243], 0
    buffer_load_dwordx4 v[136:139], v1, s[48:51], s93 offen offset:2048 sc1
    v_mfma_f32_32x32x16_bf16 v[80:95], a[4:7], v[240:243], 0
    v_mfma_f32_32x32x16_bf16 v[64:79], a[8:11], v[244:247], v[64:79]
    buffer_load_dwordx4 v[140:143], v1, s[48:51], s93 offen offset:3072 sc1
    s_waitcnt lgkmcnt(0)
    s_nop 2
    v_add_f32 v96, v96, v48
    v_mfma_f32_32x32x16_bf16 v[80:95], a[12:15], v[244:247], v[80:95]
    v_add_f32_e64 v97, v97, v49
    v_cvt_pk_bf16_f32 v168, v96, v97
    v_add_f32 v98, v98, v50
    v_add_f32 v99, v99, v51
    v_cvt_pk_bf16_f32 v169, v98, v99
    v_mfma_f32_32x32x16_bf16 v[64:79], a[16:19], v[248:251], v[64:79]
    s_mov_b32 m0, s91
    s_nop 0
    buffer_load_dwordx4 v27, s[48:51], s92 offen sc1 lds
    v_add_f32_e64 v100, v100, v52
    v_mfma_f32_32x32x16_bf16 v[80:95], a[20:23], v[248:251], v[80:95]
    v_add_f32_e64 v101, v101, v53
    v_cvt_pk_bf16_f32 v170, v100, v101
    v_mfma_f32_32x32x16_bf16 v[64:79], a[24:27], v[252:255], v[64:79]
    buffer_load_dwordx4 v27, s[48:51], s90 offen offset:1024 sc1 lds
    v_mfma_f32_32x32x16_bf16 v[80:95], a[28:31], v[252:255], v[80:95]
    s_waitcnt vmcnt(27)
    v_mfma_f32_32x32x16_bf16 v[64:79], a[32:35], v[156:159], v[64:79]
    buffer_store_dwordx4 v[168:171], v1, s[48:51], s84 offen offset:0 sc1
    v_mfma_f32_32x32x16_bf16 v[80:95], a[36:39], v[156:159], v[80:95]
    v_add_f32 v102, v102, v54
    v_add_f32_e64 v103, v103, v55
    v_cvt_pk_bf16_f32 v172, v102, v103
    v_add_f32 v104, v104, v56
    v_add_f32 v105, v105, v57
    v_cvt_pk_bf16_f32 v173, v104, v105
    v_add_f32 v106, v106, v58
    v_add_f32 v107, v107, v59
    v_cvt_pk_bf16_f32 v174, v106, v107
    s_waitcnt vmcnt(27)
    v_mfma_f32_32x32x16_bf16 v[64:79], a[40:43], v[192:195], v[64:79]
    buffer_store_dwordx4 v[172:175], v1, s[48:51], s84 offen offset:1024 sc1
    v_mfma_f32_32x32x16_bf16 v[80:95], a[44:47], v[192:195], v[80:95]
    v_add_f32 v108, v108, v60
    v_add_f32_e64 v109, v109, v61
    v_cvt_pk_bf16_f32 v176, v108, v109
    v_add_f32 v110, v110, v62
    v_add_f32 v111, v111, v63
    v_cvt_pk_bf16_f32 v177, v110, v111
    s_waitcnt vmcnt(27)
    v_mfma_f32_32x32x16_bf16 v[64:79], a[48:51], v[196:199], v[64:79]
    buffer_store_dwordx4 v[176:179], v1, s[48:51], s84 offen offset:2048 sc1
    v_mfma_f32_32x32x16_bf16 v[80:95], a[52:55], v[196:199], v[80:95]
    ds_read2_b64 v[128:131], v24 offset0:0 offset1:2
    ds_read2_b64 v[132:135], v24 offset0:4 offset1:6
    s_waitcnt vmcnt(26)
    v_mfma_f32_32x32x16_bf16 v[64:79], a[56:59], v[200:203], v[64:79]
    v_mfma_f32_32x32x16_bf16 v[80:95], a[60:63], v[200:203], v[80:95]
    s_waitcnt lgkmcnt(0)
    v_lshlrev_b32 v112, 16, v128
    v_and_b32 v113, 0xffff0000, v128
    v_lshlrev_b32_e64 v114, 16, v129
    v_and_b32 v115, 0xffff0000, v129
    v_lshlrev_b32 v116, 16, v130
    s_waitcnt vmcnt(24)
    v_mfma_f32_32x32x16_bf16 v[64:79], a[64:67], v[204:207], v[64:79]
    v_and_b32 v117, 0xffff0000, v130
    v_lshlrev_b32_e64 v118, 16, v131
    v_and_b32 v119, 0xffff0000, v131
    v_lshlrev_b32_e64 v120, 16, v132
    v_and_b32 v121, 0xffff0000, v132
    s_waitcnt vmcnt(23)
    v_mfma_f32_32x32x16_bf16 v[64:79], a[72:75], v[208:211], v[64:79]
    v_lshlrev_b32 v122, 16, v133
    v_and_b32 v123, 0xffff0000, v133
    v_lshlrev_b32_e64 v124, 16, v134
    v_and_b32 v125, 0xffff0000, v134
    v_lshlrev_b32 v126, 16, v135
    s_waitcnt vmcnt(22)
    v_mfma_f32_32x32x16_bf16 v[64:79], a[80:83], v[212:215], v[64:79]
    v_and_b32 v127, 0xffff0000, v135
    v_mul_f32 v112, v30, v112
    v_mul_f32 v113, v30, v113
    v_mul_f32 v114, v30, v114
    v_mul_f32 v115, v30, v115
    s_waitcnt vmcnt(21)
    v_mfma_f32_32x32x16_bf16 v[64:79], a[88:91], v[216:219], v[64:79]
    v_mul_f32 v116, v30, v116
    v_mul_f32 v117, v30, v117
    v_mul_f32 v118, v30, v118
    v_mul_f32 v119, v30, v119
    v_mul_f32 v120, v30, v120
    s_waitcnt vmcnt(20)
    v_mfma_f32_32x32x16_bf16 v[64:79], a[96:99], v[220:223], v[64:79]
    v_mul_f32 v121, v30, v121
    v_mul_f32 v122, v30, v122
    v_mul_f32 v123, v30, v123
    v_mul_f32 v124, v30, v124
    v_mul_f32 v125, v30, v125
    s_waitcnt vmcnt(19)
    v_mfma_f32_32x32x16_bf16 v[64:79], a[104:107], a[224:227], v[64:79]
    v_mul_f32 v126, v30, v126
    v_mul_f32 v127, v30, v127
    s_waitcnt vmcnt(18)
    v_mfma_f32_32x32x16_bf16 v[64:79], a[112:115], a[228:231], v[64:79]
    s_waitcnt vmcnt(17)
    v_mfma_f32_32x32x16_bf16 v[64:79], a[120:123], v[160:163], v[64:79]
    s_waitcnt vmcnt(16)
    v_mfma_f32_32x32x16_bf16 v[64:79], a[128:131], v[164:167], v[64:79]
    s_waitcnt vmcnt(15)
    v_mfma_f32_32x32x16_bf16 v[64:79], a[136:139], v[224:227], v[64:79]
    s_waitcnt vmcnt(14)
    v_mfma_f32_32x32x16_bf16 v[64:79], a[144:147], v[228:231], v[64:79]
    s_waitcnt vmcnt(13)
    v_mfma_f32_32x32x16_bf16 v[64:79], a[152:155], v[232:235], v[64:79]
    s_waitcnt vmcnt(12)
    v_mfma_f32_32x32x16_bf16 v[64:79], a[160:163], a[232:235], v[64:79]
    s_waitcnt vmcnt(3)
    ds_read2_b32 v[128:129], v22 offset0:0 offset1:32
    ds_read2_b32 v[130:131], v22 offset0:128 offset1:160
    v_mfma_f32_32x32x16_bf16 v[64:79], a[168:171], a[236:239], v[64:79]
    ds_read2_b32 v[132:133], v25 offset0:0 offset1:32
    ds_read2_b32 v[134:135], v25 offset0:128 offset1:160
    v_mfma_f32_32x32x16_bf16 v[64:79], a[176:179], a[240:243], v[64:79]
    v_mfma_f32_32x32x16_bf16 v[64:79], a[184:187], a[244:247], v[64:79]
    v_mfma_f32_32x32x16_bf16 v[64:79], a[192:195], a[248:251], v[64:79]
    s_waitcnt lgkmcnt(0)
    v_max3_u32 v26, v128, v129, v130
    v_max3_u32 v19, v131, v132, v133
    v_max3_u32 v26, v26, v134, v135
    v_max_u32_e64 v26, v26, v19
    v_mfma_f32_32x32x16_bf16 v[64:79], a[200:203], a[252:255], v[64:79]
    v_cmp_eq_u32 vcc, -1, v26
    s_cbranch_vccnz SLOW_A
BACK_A:
    v_lshlrev_b32_e64 v26, 16, v128
    v_and_b32 v19, 0xffff0000, v128
    v_fmac_f32 v112, v29, v26
    v_mfma_f32_32x32x16_bf16 v[64:79], a[208:211], v[136:139], v[64:79]
    v_fmac_f32 v113, v29, v19
    v_lshlrev_b32_e64 v26, 16, v129
    v_and_b32 v19, 0xffff0000, v129
    v_fmac_f32 v114, v29, v26
    v_fmac_f32 v115, v29, v19
    v_mfma_f32_32x32x16_bf16 v[64:79], a[216:219], v[140:143], v[64:79]
    v_lshlrev_b32_e64 v26, 16, v130
    v_and_b32 v19, 0xffff0000, v130
    v_fmac_f32 v116, v29, v26
    v_fmac_f32 v117, v29, v19
    v_lshlrev_b32_e64 v26, 16, v131
    v_and_b32 v19, 0xffff0000, v131
    v_mfma_f32_32x32x16_bf16 v[80:95], a[68:71], v[204:207], v[80:95]
    v_fmac_f32 v118, v29, v26
    v_fmac_f32 v119, v29, v19
    v_lshlrev_b32_e64 v26, 16, v132
    v_and_b32 v19, 0xffff0000, v132
    v_fmac_f32 v120, v29, v26
    v_fmac_f32 v121, v29, v19
    v_mfma_f32_32x32x16_bf16 v[80:95], a[76:79], v[208:211], v[80:95]
    v_lshlrev_b32_e64 v26, 16, v133
    v_and_b32 v19, 0xffff0000, v133
    v_fmac_f32 v122, v29, v26
    v_fmac_f32 v123, v29, v19
    v_lshlrev_b32_e64 v26, 16, v134
    v_and_b32 v19, 0xffff0000, v134
    v_mfma_f32_32x32x16_bf16 v[80:95], a[84:87], v[212:215], v[80:95]
    ds_write_b128 v4, v[64:67] offset:16384
    v_mfma_f32_32x32x16_bf16 v[80:95], a[92:95], v[216:219], v[80:95]
    buffer_load_dwordx4 v[180:183], v1, s[48:51], s19 offen offset:0 sc1
    v_fmac_f32 v124, v29, v26
    v_fmac_f32 v125, v29, v19
    v_mfma_f32_32x32x16_bf16 v[80:95], a[100:103], v[220:223], v[80:95]
    ds_write_b128 v4, v[68:71] offset:17408
    v_mfma_f32_32x32x16_bf16 v[80:95], a[108:111], a[224:227], v[80:95]
    buffer_load_dwordx4 v[184:187], v1, s[48:51], s19 offen offset:1024 sc1
    v_lshlrev_b32_e64 v26, 16, v135
    v_and_b32 v19, 0xffff0000, v135
    v_mfma_f32_32x32x16_bf16 v[80:95], a[116:119], a[228:231], v[80:95]
    ds_write_b128 v4, v[72:75] offset:18432
    v_mfma_f32_32x32x16_bf16 v[80:95], a[124:127], v[160:163], v[80:95]
    buffer_load_dwordx4 v[188:191], v1, s[48:51], s19 offen offset:2048 sc1
    v_fmac_f32 v126, v29, v26
    v_fmac_f32 v127, v29, v19
    v_mfma_f32_32x32x16_bf16 v[80:95], a[132:135], v[164:167], v[80:95]
    ds_write_b128 v4, v[76:79] offset:19456
    v_mfma_f32_32x32x16_bf16 v[80:95], a[140:143], v[224:227], v[80:95]
    v_mfma_f32_32x32x16_bf16 v[80:95], a[148:151], v[228:231], v[80:95]
    s_waitcnt lgkmcnt(0)
    s_barrier
    ds_read_b128 v[96:99], v5 offset:16384
    ds_read_b128 v[100:103], v5 offset:17408
    v_mfma_f32_32x32x16_bf16 v[80:95], a[156:159], v[232:235], v[80:95]
    ds_read_b128 v[104:107], v5 offset:18432
    ds_read_b128 v[108:111], v5 offset:19456
    v_mfma_f32_32x32x16_bf16 v[80:95], a[164:167], a[232:235], v[80:95]
    v_mfma_f32_32x32x16_bf16 v[80:95], a[172:175], a[236:239], v[80:95]
    s_waitcnt lgkmcnt(0)
    v_fmac_f32 v112, v30, v96
    v_fmac_f32 v113, v30, v97
    v_fmac_f32 v114, v30, v98
    v_fmac_f32 v115, v30, v99
    v_fmac_f32 v116, v30, v100
    v_fmac_f32 v117, v30, v101
    v_mfma_f32_32x32x16_bf16 v[80:95], a[180:183], a[240:243], v[80:95]
    v_fmac_f32 v118, v30, v102
    v_fmac_f32 v119, v30, v103
    v_fmac_f32 v120, v30, v104
    v_fmac_f32 v121, v30, v105
    v_fmac_f32 v122, v30, v106
    v_fmac_f32 v123, v30, v107
    v_mfma_f32_32x32x16_bf16 v[80:95], a[188:191], a[244:247], v[80:95]
    v_fmac_f32 v124, v30, v108
    v_fmac_f32 v125, v30, v109
    v_fmac_f32 v126, v30, v110
    v_fmac_f32 v127, v30, v111
    v_mfma_f32_32x32x16_bf16 v[80:95], a[196:199], a[248:251], v[80:95]
    v_mfma_f32_32x32x16_bf16 v[80:95], a[204:207], a[252:255], v[80:95]
    v_mfma_f32_32x32x16_bf16 v[80:95], a[212:215], v[136:139], v[80:95]
    v_mfma_f32_32x32x16_bf16 v[80:95], a[220:223], v[140:143], v[80:95]
    s_nop 11
    v_pk_fma_f32 v[112:113], v[80:81], v[30:31], v[112:113] op_sel:[0,0,0] op_sel_hi:[1,0,1]
    v_pk_fma_f32 v[114:115], v[82:83], v[30:31], v[114:115] op_sel:[0,0,0] op_sel_hi:[1,0,1]
    v_pk_fma_f32 v[116:117], v[84:85], v[30:31], v[116:117] op_sel:[0,0,0] op_sel_hi:[1,0,1]
    v_pk_fma_f32 v[118:119], v[86:87], v[30:31], v[118:119] op_sel:[0,0,0] op_sel_hi:[1,0,1]
    v_pk_fma_f32 v[120:121], v[88:89], v[30:31], v[120:121] op_sel:[0,0,0] op_sel_hi:[1,0,1]
    v_pk_fma_f32 v[122:123], v[90:91], v[30:31], v[122:123] op_sel:[0,0,0] op_sel_hi:[1,0,1]
    v_pk_fma_f32 v[124:125], v[92:93], v[30:31], v[124:125] op_sel:[0,0,0] op_sel_hi:[1,0,1]
    v_pk_fma_f32 v[126:127], v[94:95], v[30:31], v[126:127] op_sel:[0,0,0] op_sel_hi:[1,0,1]
    s_waitcnt vmcnt(0)
    v_bitop3_b32 v26, v183, v187, v2 bitop3:0x7e
    v_bitop3_b32 v26, v26, v191, v2 bitop3:0xf6
    v_cmp_ne_u32 vcc, 0, v26
    s_cbranch_vccnz SLOW_PX
BACK_PX:
    v_dot2_f32_bf16 v112, v180, v31, v112
    v_dot2_f32_bf16 v113, v180, v30, v113
    v_dot2_f32_bf16 v114, v181, v31, v114
    v_dot2_f32_bf16 v115, v181, v30, v115
    v_dot2_f32_bf16 v116, v182, v31, v116
    v_dot2_f32_bf16 v117, v182, v30, v117
    v_dot2_f32_bf16 v118, v184, v31, v118
    v_dot2_f32_bf16 v119, v184, v30, v119
    v_dot2_f32_bf16 v120, v185, v31, v120
    v_dot2_f32_bf16 v121, v185, v30, v121
    v_dot2_f32_bf16 v122, v186, v31, v122
    v_dot2_f32_bf16 v123, v186, v30, v123
    v_dot2_f32_bf16 v124, v188, v31, v124
    v_dot2_f32_bf16 v125, v188, v30, v125
    v_dot2_f32_bf16 v126, v189, v31, v126
    v_dot2_f32_bf16 v127, v189, v30, v127
    v_cvt_pk_bf16_f32 v168, v112, v113
    v_cvt_pk_bf16_f32 v169, v114, v115
    v_cvt_pk_bf16_f32 v170, v116, v117
    v_cvt_pk_bf16_f32 v171, v118, v119
    v_cvt_pk_bf16_f32 v172, v120, v121
    v_cvt_pk_bf16_f32 v173, v122, v123
    v_cvt_pk_bf16_f32 v174, v124, v125
    v_cvt_pk_bf16_f32 v175, v126, v127
    v_permlane32_swap_b32 v168, v170
    v_permlane32_swap_b32 v169, v171
    v_permlane32_swap_b32 v172, v174
    v_permlane32_swap_b32 v173, v175
    s_nop 0
    v_permlane16_swap_b32 v168, v172
    v_permlane16_swap_b32 v169, v173
    v_permlane16_swap_b32 v170, v174
    v_permlane16_swap_b32 v171, v175
    buffer_store_dwordx4 v[168:171], v23, s[52:55], 0 offen sc1
    buffer_store_dwordx4 v[172:175], v23, s[52:55], s89 offen sc1
L_END:
    s_endpgm
L_SERVICE:
    s_mov_b64 s[44:45], s[24:25]
    s_mov_b64 s[46:47], s[42:43]
    s_mov_b64 s[48:49], s[34:35]
    s_mov_b32 s50, 268435456
    s_mov_b32 s51, s39
    s_mov_b64 s[52:53], s[30:31]
    s_mov_b64 s[54:55], s[38:39]
    v_lshlrev_b32 v1, 4, v0
    v_mov_b32 v12, 0
    s_lshl2_add_u32 s81, s2, s56
    s_lshl_b32 s81, s81, 11
    s_add_u32 s81, s81, 10485760
    s_xor_b32 s82, s60, 3
    s_lshl1_add_u32 s83, s59, s87
    s_lshl_b32 s72, s87, 15
    s_lshl_b32 s61, s82, 7
    s_add_u32 s72, s72, s61
    s_mul_i32 s62, s57, 14
    s_add_u32 s62, s62, s95
    s_lshl_b32 s62, s62, 12
    s_max_u32 s61, s60, 1
    s_sub_u32 s61, s61, 1
    s_lshl_b32 s74, s61, 13
    s_add_u32 s74, s74, s62
    s_and_b32 s63, s59, 3
    s_mul_i32 s63, s63, 3
    s_lshr_b32 s63, s63, 1
    s_lshl_b32 s63, s63, 2
    s_mov_b32 s64, 0x21654321
    s_movk_i32 s65, 0x6543
    s_lshr_b64 s[64:65], s[64:65], s63
    s_mul_i32 s61, s61, 0x111111
    s_add_u32 s61, s61, s64
    s_add_u32 s63, s61, 0x111111
    s_lshr_b32 s63, s63, 3
    s_and_b32 s63, s63, 0x111111
    s_add_u32 s61, s61, s63
    s_bfe_u32 s75, s61, 0x30000
    s_lshl_b32 s75, s75, 13
    s_add_u32 s75, s75, s62
    s_bfe_u32 s76, s61, 0x30004
    s_lshl_b32 s76, s76, 13
    s_add_u32 s76, s76, s62
    s_bfe_u32 s77, s61, 0x30008
    s_lshl_b32 s77, s77, 13
    s_add_u32 s77, s77, s62
    s_bfe_u32 s78, s61, 0x3000c
    s_lshl_b32 s78, s78, 13
    s_add_u32 s78, s78, s62
    s_bfe_u32 s79, s61, 0x30010
    s_lshl_b32 s79, s79, 13
    s_add_u32 s79, s79, s62
    s_bfe_u32 s80, s61, 0x30014
    s_lshl_b32 s80, s80, 13
    s_add_u32 s80, s80, s62
    s_mul_i32 s85, s83, 229376
    s_add_u32 s86, s85, 114688
    v_lshrrev_b32 v44, 3, v0
    v_and_b32 v45, 7, v0
    v_bfe_u32 v46, v0, 4, 1
    v_lshlrev_b32 v47, 2, v46
    v_xor_b32 v47, v47, v45
    v_lshlrev_b32_e64 v47, 4, v47
    v_lshl_add_u32 v4, v44, 10, v47
    v_add_u32 v5, 7168, v4
    v_add_u32 v6, 14336, v4
    v_add_u32 v7, 21504, v4
    v_bfe_u32 v44, v0, 2, 2
    v_lshrrev_b32_e64 v45, 5, v0
    v_lshl_add_u32 v45, v45, 2, v44
    v_lshlrev_b32_e64 v45, 7, v45
    v_lshl_add_u32 v45, v46, 5, v45
    v_and_b32_e64 v46, 3, v0
    v_lshl_add_u32 v45, v46, 3, v45
    v_lshrrev_b32_e64 v44, 1, v44
    v_lshl_add_u32 v45, v44, 6, v45
    s_mul_i32 s61, s95, 4160
    v_xor_b32 v9, s61, v45
    v_xor_b32 v8, 64, v9
    v_add_u32 v10, 98304, v8
    v_add_u32 v11, 98304, v9
    v_and_b32 v44, 3, v0
    v_lshlrev_b32 v45, 1, v44
    v_sub_u32 v45, s60, v45
    v_and_b32 v45, 7, v45
    v_lshl_or_b32 v44, v45, 2, v44
    v_bfe_u32 v45, v0, 2, 2
    v_lshl_or_b32 v44, v44, 2, v45
    s_bfe_u32 s61, s58, 0x10001
    v_lshl_or_b32 v14, v44, 1, s61
    v_lshlrev_b32_e64 v14, 7, v14
    v_add_u32 v14, 14811136, v14
    s_lshl_b32 s61, s56, 2
    s_bfm_b64 s[14:15], 4, s61
    v_cndmask_b32 v14, -1, v14, s[14:15]
    v_and_b32 v236, 7, v0
    v_lshrrev_b32 v233, 1, v236
    v_and_b32_e64 v234, 1, v0
    v_lshl_or_b32 v233, v234, 2, v233
    v_lshrrev_b32 v234, 5, v0
    s_lshl1_add_u32 s61, s57, s95
    s_lshl_b32 s62, s61, 1
    v_bitop3_b32 v233, v233, v234, s62 bitop3:0x96
    v_bfe_u32 v234, v0, 3, 2
    v_lshl_or_b32 v233, v233, 2, v234
    v_lshl_add_u32 v234, s87, 3, v236
    v_lshlrev_b32 v234, 10, v234
    v_lshl_add_u32 v232, v233, 2, v234
    v_xor_b32 v233, 16, v232
    v_xor_b32 v234, 32, v232
    v_xor_b32 v235, 48, v232
    s_lshl2_add_u32 s6, s19, s61
    s_lshl1_add_u32 s61, s59, s87
    s_lshl_b32 s8, s2, 7
    s_add_u32 s8, s8, 14811136
    s_lshl_b32 s62, s56, 28
    s_add_u32 s8, s8, s62
    s_lshl_b32 s6, s6, 9
    s_add_u32 s6, s6, s61
    s_lshl_b32 s6, s6, 7
    s_add_u32 s6, s6, 8388608
    s_add_u32 s7, s6, 4096
    s_lshl_b32 s61, s57, 2
    s_xor_b32 s61, s61, 4
    v_xor_b32 v236, s61, v236
    v_lshrrev_b32 v237, 3, v0
    v_lshlrev_b32 v237, 13, v237
    v_lshl_add_u32 v236, v236, 4, v237
    s_mov_b32 s10, 0x05040100
    s_mov_b32 s11, 0x07060302
    s_min_u32 s61, s59, 13
    s_mul_i32 s62, s57, 14
    s_add_u32 s89, s62, s61
    s_lshl2_add_u32 s61, s89, s56
    s_lshl_b32 s61, s61, 4
    v_and_b32 v29, 15, v0
    v_mul_u32_u24 v58, 1040, v29
    v_add_u32 v24, s61, v29
    v_lshlrev_b32 v25, 1, v24
    v_lshlrev_b32_e64 v24, 4, v24
    v_add_u32 v24, 14712832, v24
    s_lshl2_add_u32 s61, s93, s56
    s_lshl_b32 s61, s61, 8
    s_add_u32 s61, s61, 14680064
    v_lshl_add_u32 v29, v29, 4, s61
    v_lshrrev_b32_e64 v20, 3, v0
    v_mul_u32_u24 v21, 3584, v20
    v_and_b32 v22, 7, v0
    v_and_b32 v20, 6, v20
    v_xor_b32_e64 v22, v22, v20
    v_lshl_add_u32 v20, v22, 4, v21
    v_add_u32 v21, 27648, v20
    v_add_u32 v22, 55296, v20
    v_add_u32 v23, 82944, v20
    s_mul_i32 s62, s56, 458752
    s_lshl_b32 s89, s89, 7
    s_add_u32 s89, s89, s62
    s_lshl_b32 s92, s56, 14
    s_mov_b32 s18, 268435456
    s_mul_i32 s61, s56, 2176
    s_add_u32 s61, s61, 82944
    v_add_u32 v52, s61, v1
    v_mov_b32 v36, 0x3f803f80
    v_mov_b32 v37, 0x3f803f80
    v_mov_b32 v38, 0x3f803f80
    v_mov_b32 v39, 0x3f803f80
    ds_write_b128 v52, v[36:39] offset:1088
    v_lshrrev_b32 v56, 4, v0
    v_and_b32 v57, 1, v0
    v_mul_u32_u24 v57, 1088, v57
    v_lshl_add_u32 v57, v56, 4, v57
    v_add_u32_e64 v57, s61, v57
    v_lshl_add_u32 v58, v56, 4, v58
    v_add_u32 v58, s91, v58
    v_lshrrev_b32 v31, 2, v0
    v_bfe_u32 v28, v0, 3, 2
    v_xor_b32 v28, s56, v28
    v_lshlrev_b32 v28, 5, v28
    v_lshl_add_u32 v31, v31, 7, v28
    v_and_b32_e64 v28, 3, v0
    v_lshl_add_u32 v31, v28, 3, v31
    v_add_u32 v31, 98304, v31
    s_add_u32 m0, m0, 4112
    s_add_u32 s90, s90, 4096
    buffer_load_dwordx4 v1, s[36:39], s90 offen offset:0 lds
    s_add_u32 m0, m0, 16
    s_nop 0
    buffer_load_dwordx4 v1, s[36:39], s90 offen offset:1024 lds
    s_add_u32 m0, m0, 16
    s_nop 0
    buffer_load_dwordx4 v1, s[36:39], s90 offen offset:2048 lds
    s_add_u32 m0, m0, 16
    s_nop 0
    buffer_load_dwordx4 v1, s[36:39], s90 offen offset:3072 lds
    s_add_u32 m0, m0, 4112
    s_add_u32 s90, s90, 4096
    buffer_load_dwordx4 v1, s[36:39], s90 offen offset:0 lds
    s_add_u32 m0, m0, 16
    s_nop 0
    buffer_load_dwordx4 v1, s[36:39], s90 offen offset:1024 lds
    s_add_u32 m0, m0, 16
    s_nop 0
    buffer_load_dwordx4 v1, s[36:39], s90 offen offset:2048 lds
    s_add_u32 m0, m0, 16
    s_nop 0
    buffer_load_dwordx4 v1, s[36:39], s90 offen offset:3072 lds
    s_add_u32 m0, m0, 4112
    s_add_u32 s90, s90, 4096
    buffer_load_dwordx4 v1, s[36:39], s90 offen offset:0 lds
    s_add_u32 m0, m0, 16
    s_nop 0
    buffer_load_dwordx4 v1, s[36:39], s90 offen offset:1024 lds
    s_add_u32 m0, m0, 16
    s_nop 0
    buffer_load_dwordx4 v1, s[36:39], s90 offen offset:2048 lds
    s_add_u32 m0, m0, 16
    s_nop 0
    buffer_load_dwordx4 v1, s[36:39], s90 offen offset:3072 lds
    global_load_dwordx4 v[144:147], v1, s[28:29]
    global_load_ushort v26, v25, s[22:23]
    global_load_dword v2, v12, s[32:33] sc1
    s_waitcnt vmcnt(19)
    s_barrier
    ds_read2_b32 v[160:161], v232 offset0:0 offset1:32
    ds_read2_b32 v[162:163], v233 offset0:64 offset1:96
    ds_read2_b32 v[164:165], v234 offset0:128 offset1:160
    ds_read2_b32 v[166:167], v235 offset0:192 offset1:224
    s_add_u32 m0, s92, 98304
    s_add_u32 s3, s89, 0
    buffer_load_dwordx4 v20, s[40:43], s3 offen offset:0 lds
    buffer_load_dwordx4 v21, s[40:43], s3 offen offset:1024 lds
    buffer_load_dwordx4 v22, s[40:43], s3 offen offset:2048 lds
    buffer_load_dwordx4 v23, s[40:43], s3 offen offset:3072 lds
    s_waitcnt lgkmcnt(0)
    v_perm_b32 v168, v161, v160, s10
    v_perm_b32 v169, v163, v162, s10
    v_perm_b32 v170, v165, v164, s10
    v_perm_b32 v171, v167, v166, s10
    v_perm_b32 v172, v161, v160, s11
    v_perm_b32 v173, v163, v162, s11
    v_perm_b32 v174, v165, v164, s11
    v_perm_b32 v175, v167, v166, s11
    buffer_store_dwordx4 v[168:171], v236, s[48:51], s6 offen sc1
    buffer_store_dwordx4 v[172:175], v236, s[48:51], s7 offen sc1
    v_mov_b32 v228, -1
    v_mov_b32 v229, -1
    v_mov_b32 v230, -1
    v_mov_b32 v231, -1
    buffer_store_dwordx4 v[228:231], v1, s[48:51], s81 offen offset:0 sc1
    buffer_store_dwordx4 v[228:231], v1, s[48:51], s81 offen offset:1024 sc1
    s_add_u32 m0, s92, 102400
    s_add_u32 s3, s89, 114688
    buffer_load_dwordx4 v20, s[40:43], s3 offen offset:0 lds
    buffer_load_dwordx4 v21, s[40:43], s3 offen offset:1024 lds
    buffer_load_dwordx4 v22, s[40:43], s3 offen offset:2048 lds
    buffer_load_dwordx4 v23, s[40:43], s3 offen offset:3072 lds
    s_waitcnt vmcnt(12)
    ds_write_b128 v52, v[144:147]
    s_add_u32 m0, s92, 106496
    s_add_u32 s3, s89, 229376
    buffer_load_dwordx4 v20, s[40:43], s3 offen offset:0 lds
    ds_read_b128 v[64:67], v58 offset:16384
    ds_read_b128 v[96:99], v57 offset:0
    ds_read_b128 v[68:71], v58 offset:16448
    ds_read_b128 v[100:103], v57 offset:64
    ds_read_b128 v[72:75], v58 offset:16512
    ds_read_b128 v[104:107], v57 offset:128
    ds_read_b128 v[76:79], v58 offset:16576
    ds_read_b128 v[108:111], v57 offset:192
    buffer_load_dwordx4 v21, s[40:43], s3 offen offset:1024 lds
    ds_read_b128 v[80:83], v58 offset:16640
    ds_read_b128 v[112:115], v57 offset:256
    ds_read_b128 v[84:87], v58 offset:16704
    ds_read_b128 v[116:119], v57 offset:320
    s_waitcnt lgkmcnt(10)
    v_mfma_f32_16x16x32_bf16 v[40:43], v[64:67], v[64:67], 0
    v_mfma_f32_16x16x32_bf16 v[44:47], v[96:99], v[64:67], 0
    ds_read_b128 v[88:91], v58 offset:16768
    ds_read_b128 v[120:123], v57 offset:384
    buffer_load_dwordx4 v22, s[40:43], s3 offen offset:2048 lds
    s_waitcnt lgkmcnt(10)
    v_mfma_f32_16x16x32_bf16 v[40:43], v[68:71], v[68:71], v[40:43]
    v_mfma_f32_16x16x32_bf16 v[44:47], v[100:103], v[68:71], v[44:47]
    ds_read_b128 v[92:95], v58 offset:16832
    ds_read_b128 v[124:127], v57 offset:448
    s_waitcnt lgkmcnt(10)
    v_mfma_f32_16x16x32_bf16 v[40:43], v[72:75], v[72:75], v[40:43]
    v_mfma_f32_16x16x32_bf16 v[44:47], v[104:107], v[72:75], v[44:47]
    ds_read_b128 v[64:67], v58 offset:16896
    ds_read_b128 v[96:99], v57 offset:512
    buffer_load_dwordx4 v23, s[40:43], s3 offen offset:3072 lds
    s_waitcnt lgkmcnt(10)
    v_mfma_f32_16x16x32_bf16 v[40:43], v[76:79], v[76:79], v[40:43]
    v_mfma_f32_16x16x32_bf16 v[44:47], v[108:111], v[76:79], v[44:47]
    ds_read_b128 v[68:71], v58 offset:16960
    ds_read_b128 v[100:103], v57 offset:576
    s_waitcnt lgkmcnt(10)
    v_mfma_f32_16x16x32_bf16 v[40:43], v[80:83], v[80:83], v[40:43]
    v_mfma_f32_16x16x32_bf16 v[44:47], v[112:115], v[80:83], v[44:47]
    ds_read_b128 v[72:75], v58 offset:17024
    ds_read_b128 v[104:107], v57 offset:640
    s_add_u32 m0, s92, 110592
    s_add_u32 s3, s89, 344064
    buffer_load_dwordx4 v20, s[40:43], s3 offen offset:0 lds
    s_waitcnt lgkmcnt(10)
    v_mfma_f32_16x16x32_bf16 v[40:43], v[84:87], v[84:87], v[40:43]
    v_mfma_f32_16x16x32_bf16 v[44:47], v[116:119], v[84:87], v[44:47]
    ds_read_b128 v[76:79], v58 offset:17088
    ds_read_b128 v[108:111], v57 offset:704
    s_waitcnt lgkmcnt(10)
    v_mfma_f32_16x16x32_bf16 v[40:43], v[88:91], v[88:91], v[40:43]
    v_mfma_f32_16x16x32_bf16 v[44:47], v[120:123], v[88:91], v[44:47]
    ds_read_b128 v[80:83], v58 offset:17152
    ds_read_b128 v[112:115], v57 offset:768
    buffer_load_dwordx4 v21, s[40:43], s3 offen offset:1024 lds
    s_waitcnt lgkmcnt(10)
    v_mfma_f32_16x16x32_bf16 v[40:43], v[92:95], v[92:95], v[40:43]
    v_mfma_f32_16x16x32_bf16 v[44:47], v[124:127], v[92:95], v[44:47]
    ds_read_b128 v[84:87], v58 offset:17216
    ds_read_b128 v[116:119], v57 offset:832
    s_waitcnt lgkmcnt(10)
    v_mfma_f32_16x16x32_bf16 v[40:43], v[64:67], v[64:67], v[40:43]
    v_mfma_f32_16x16x32_bf16 v[44:47], v[96:99], v[64:67], v[44:47]
    ds_read_b128 v[88:91], v58 offset:17280
    ds_read_b128 v[120:123], v57 offset:896
    buffer_load_dwordx4 v22, s[40:43], s3 offen offset:2048 lds
    s_waitcnt lgkmcnt(10)
    v_mfma_f32_16x16x32_bf16 v[40:43], v[68:71], v[68:71], v[40:43]
    v_mfma_f32_16x16x32_bf16 v[44:47], v[100:103], v[68:71], v[44:47]
    ds_read_b128 v[92:95], v58 offset:17344
    ds_read_b128 v[124:127], v57 offset:960
    s_waitcnt lgkmcnt(10)
    v_mfma_f32_16x16x32_bf16 v[40:43], v[72:75], v[72:75], v[40:43]
    v_mfma_f32_16x16x32_bf16 v[44:47], v[104:107], v[72:75], v[44:47]
    s_waitcnt lgkmcnt(8)
    v_mfma_f32_16x16x32_bf16 v[40:43], v[76:79], v[76:79], v[40:43]
    v_mfma_f32_16x16x32_bf16 v[44:47], v[108:111], v[76:79], v[44:47]
    buffer_load_dwordx4 v23, s[40:43], s3 offen offset:3072 lds
    s_waitcnt lgkmcnt(6)
    v_mfma_f32_16x16x32_bf16 v[40:43], v[80:83], v[80:83], v[40:43]
    v_mfma_f32_16x16x32_bf16 v[44:47], v[112:115], v[80:83], v[44:47]
    s_waitcnt lgkmcnt(4)
    v_mfma_f32_16x16x32_bf16 v[40:43], v[84:87], v[84:87], v[40:43]
    v_mfma_f32_16x16x32_bf16 v[44:47], v[116:119], v[84:87], v[44:47]
    s_waitcnt lgkmcnt(2)
    v_mfma_f32_16x16x32_bf16 v[40:43], v[88:91], v[88:91], v[40:43]
    v_mfma_f32_16x16x32_bf16 v[44:47], v[120:123], v[88:91], v[44:47]
    s_waitcnt lgkmcnt(0)
    v_mfma_f32_16x16x32_bf16 v[40:43], v[92:95], v[92:95], v[40:43]
    v_mfma_f32_16x16x32_bf16 v[44:47], v[124:127], v[92:95], v[44:47]
    v_cmp_eq_u32 vcc, 0, v2
    s_cbranch_vccnz SLOW_SNON
BACK_SNON:
    v_cmp_eq_u32 s[64:65], 1, v28
    v_cmp_eq_u32 s[66:67], 2, v28
    v_cmp_eq_u32 s[68:69], 3, v28
    v_bfe_u32 v28, v0, 2, 2
    v_cmp_eq_u32 s[70:71], v28, v56
    v_cndmask_b32 v40, v40, v41, s[64:65]
    v_cndmask_b32 v40, v40, v42, s[66:67]
    v_cndmask_b32 v40, v40, v43, s[68:69]
    v_mul_f32 v45, 0xbb000000, v45
    v_mul_f32 v40, 0x3b000000, v40
    v_fma_f32 v40, -v45, v45, v40
    v_max_f32 v40, 0, v40
    v_add_f32 v40, 0x3727c5ac, v40
    v_sqrt_f32_e64 v40, v40
    v_mul_f32 v44, 0xbfb8aa3b, v44
    v_exp_f32_e64 v44, v44
    v_cvt_pk_bf16_f32 v49, v45, v40
    v_add_f32 v44, 1.0, v44
    v_rcp_f32 v44, v44
    v_lshlrev_b32_e64 v46, 16, v49
    v_and_b32 v47, 0xffff0000, v49
    v_sub_f32 v41, v45, v46
    v_sub_f32 v42, v40, v47
    v_cvt_pk_bf16_f32 v48, v46, v41
    v_cvt_pk_bf16_f32 v50, v42, v44
    v_mov_b32 v51, v2
    s_mov_b64 exec, s[70:71]
    buffer_store_dwordx4 v[48:51], v29, s[48:51], 0 offen sc1
    s_mov_b64 exec, -1
    s_waitcnt vmcnt(1)
    s_barrier
    s_mov_b64 exec, 0xff
    buffer_store_dwordx4 v[2:5], v1, s[48:51], s8 offen offset:0 sc1
    s_mov_b64 exec, -1
    ds_read_b64_tr_b16 v[64:65], v31 offset:0
    ds_read_b64_tr_b16 v[66:67], v31 offset:2048
    ds_read_b64_tr_b16 v[68:69], v31 offset:4096
    ds_read_b64_tr_b16 v[70:71], v31 offset:6144
    ds_read_b64_tr_b16 v[72:73], v31 offset:8192
    ds_read_b64_tr_b16 v[74:75], v31 offset:10240
    ds_read_b64_tr_b16 v[76:77], v31 offset:12288
    ds_read_b64_tr_b16 v[78:79], v31 offset:14336
    ds_read_b64_tr_b16 v[80:81], v31 offset:16384
    ds_read_b64_tr_b16 v[82:83], v31 offset:18432
    ds_read_b64_tr_b16 v[84:85], v31 offset:20480
    ds_read_b64_tr_b16 v[86:87], v31 offset:22528
    s_waitcnt lgkmcnt(10)
    v_mfma_f32_16x16x32_bf16 v[60:63], v[36:39], v[64:67], 0
    ds_read_b64_tr_b16 v[88:89], v31 offset:24576
    ds_read_b64_tr_b16 v[90:91], v31 offset:26624
    s_waitcnt lgkmcnt(10)
    v_mfma_f32_16x16x32_bf16 v[60:63], v[36:39], v[68:71], v[60:63]
    ds_read_b64_tr_b16 v[92:93], v31 offset:28672
    ds_read_b64_tr_b16 v[94:95], v31 offset:30720
    s_waitcnt lgkmcnt(10)
    v_mfma_f32_16x16x32_bf16 v[60:63], v[36:39], v[72:75], v[60:63]
    ds_read_b64_tr_b16 v[96:97], v31 offset:32768
    ds_read_b64_tr_b16 v[98:99], v31 offset:34816
    s_waitcnt lgkmcnt(10)
    v_mfma_f32_16x16x32_bf16 v[60:63], v[36:39], v[76:79], v[60:63]
    ds_read_b64_tr_b16 v[100:101], v31 offset:36864
    ds_read_b64_tr_b16 v[102:103], v31 offset:38912
    s_waitcnt lgkmcnt(10)
    v_mfma_f32_16x16x32_bf16 v[60:63], v[36:39], v[80:83], v[60:63]
    ds_read_b64_tr_b16 v[104:105], v31 offset:40960
    ds_read_b64_tr_b16 v[106:107], v31 offset:43008
    s_waitcnt lgkmcnt(10)
    v_mfma_f32_16x16x32_bf16 v[60:63], v[36:39], v[84:87], v[60:63]
    ds_read_b64_tr_b16 v[108:109], v31 offset:45056
    ds_read_b64_tr_b16 v[110:111], v31 offset:47104
    s_waitcnt lgkmcnt(10)
    v_mfma_f32_16x16x32_bf16 v[60:63], v[36:39], v[88:91], v[60:63]
    ds_read_b64_tr_b16 v[112:113], v31 offset:49152
    ds_read_b64_tr_b16 v[114:115], v31 offset:51200
    s_waitcnt lgkmcnt(10)
    v_mfma_f32_16x16x32_bf16 v[60:63], v[36:39], v[92:95], v[60:63]
    ds_read_b64_tr_b16 v[116:117], v31 offset:53248
    ds_read_b64_tr_b16 v[118:119], v31 offset:55296
    s_waitcnt lgkmcnt(10)
    v_mfma_f32_16x16x32_bf16 v[60:63], v[36:39], v[96:99], v[60:63]
    ds_read_b64_tr_b16 v[120:121], v31 offset:57344
    ds_read_b64_tr_b16 v[122:123], v31 offset:59392
    s_waitcnt lgkmcnt(10)
    v_mfma_f32_16x16x32_bf16 v[60:63], v[36:39], v[100:103], v[60:63]
    ds_read_b64_tr_b16 v[124:125], v31 offset:61440
    ds_read_b64_tr_b16 v[126:127], v31 offset:63488
    s_waitcnt lgkmcnt(10)
    v_mfma_f32_16x16x32_bf16 v[60:63], v[36:39], v[104:107], v[60:63]
    s_waitcnt lgkmcnt(8)
    v_mfma_f32_16x16x32_bf16 v[60:63], v[36:39], v[108:111], v[60:63]
    s_waitcnt lgkmcnt(6)
    v_mfma_f32_16x16x32_bf16 v[60:63], v[36:39], v[112:115], v[60:63]
    s_waitcnt lgkmcnt(4)
    v_mfma_f32_16x16x32_bf16 v[60:63], v[36:39], v[116:119], v[60:63]
    s_waitcnt lgkmcnt(2)
    v_mfma_f32_16x16x32_bf16 v[60:63], v[36:39], v[120:123], v[60:63]
    s_waitcnt lgkmcnt(0)
    v_mfma_f32_16x16x32_bf16 v[60:63], v[36:39], v[124:127], v[60:63]
    s_barrier
    v_lshlrev_b32 v46, 16, v26
    v_mov_b32 v54, v26
    v_mov_b32 v55, v2
    s_nop 3
    v_cvt_pk_bf16_f32 v52, v60, v60
    v_lshlrev_b32 v41, 16, v52
    v_sub_f32_e64 v41, v60, v41
    v_cvt_pk_bf16_f32 v53, v41, v46
    s_mov_b64 exec, 0xffff
    buffer_store_dwordx4 v[52:55], v24, s[48:51], 0 offen sc1
    s_mov_b64 exec, -1
    s_lshl_b32 s61, s57, 5
    s_add_u32 s61, s61, s58
    s_lshl2_add_u32 s61, s61, s56
    s_mul_i32 s61, s61, 7168
    v_lshlrev_b32_e64 v3, 10, v0
    s_mov_b64 exec, 0x7f
    buffer_load_dword v255, v3, s[44:47], s61 offen offset:384
    s_mov_b64 exec, -1
    s_mul_i32 s61, s57, 14
    s_lshl_b32 s62, s83, 5
    s_add_u32 s61, s61, s62
    s_lshl_b32 s61, s61, 8
    s_mul_i32 s62, s95, 1792
    s_add_u32 s61, s61, s62
    s_add_u32 s61, s61, 14942208
    v_lshlrev_b32_e64 v3, 7, v0
    s_mov_b64 exec, 0x3fff
    buffer_load_dword v254, v3, s[48:51], s61 offen sc1
    s_mov_b64 exec, -1
    v_and_b32 v33, 31, v0
    v_lshlrev_b32_e64 v33, 2, v33
    v_lshl_add_u32 v32, s82, 7, v33
    v_add_u32 v33, 90112, v33
    global_load_dword v32, v32, s[26:27]
    s_lshl1_add_u32 s61, s83, s57
    s_lshl_b32 s61, s61, 9
    s_add_u32 s61, s61, 14680072
    v_and_b32_e64 v34, 31, v0
    v_lshl_add_u32 v34, v34, 4, s61
    s_lshl_b32 s61, s56, 8
    s_add_u32 s61, s61, 49152
    v_lshl_add_u32 v112, v0, 2, s61
    v_xor_b32 v113, 16, v112
    v_xor_b32 v114, 32, v112
    v_xor_b32 v115, 48, v112
    v_xor_b32_e64 v116, 64, v112
    v_xor_b32 v117, 80, v112
    v_xor_b32 v118, 96, v112
    v_xor_b32 v119, 112, v112
    v_xor_b32 v120, 128, v112
    v_xor_b32 v121, 144, v112
    v_xor_b32 v122, 160, v112
    v_xor_b32 v123, 176, v112
    v_xor_b32 v124, 192, v112
    v_xor_b32 v125, 208, v112
    v_xor_b32 v126, 224, v112
    v_xor_b32 v127, 240, v112
    s_lshl4_add_u32 s61, s95, 48
    v_cmp_eq_u32 vcc, s61, v0
    v_lshlrev_b32 v240, 16, v240
    v_lshlrev_b32 v244, 16, v244
    v_mul_f32 v240, 0x3fb8aa3b, v240
    v_mul_f32 v244, 0x3fb8aa3b, v244
    v_exp_f32 v240, v240
    v_exp_f32 v244, v244
    v_lshlrev_b32 v241, 16, v241
    v_lshlrev_b32 v242, 16, v242
    v_lshlrev_b32_e64 v243, 16, v243
    v_cvt_pk_bf16_f32 v240, v244, v240
    v_lshlrev_b32_e64 v244, 16, v240
    v_and_b32 v240, 0xffff0000, v240
    v_mul_f32 v240, v240, v244
    v_mul_f32 v241, v241, v244
    v_mul_f32 v240, 0xbfb8aa3b, v240
    v_mul_f32 v241, 0.15915494, v241
    v_add_f32 v244, v244, v244
    v_mul_f32_e64 v82, v242, v244
    s_add_u32 m0, s73, 32768
    s_lshl4_add_u32 s3, s75, s72
    buffer_load_dwordx4 v4, s[44:47], s3 offen offset:0 lds
    v_mul_f32 v83, -v243, v244
    v_mul_f32 v90, 0x43800000, v240
    v_mul_f32 v91, 0x43800000, v241
    v_fract_f32 v241, v241
    v_fract_f32 v91, v91
    v_exp_f32 v240, v240
    v_exp_f32 v90, v90
    v_cos_f32 v50, v241
    v_sin_f32 v51, v241
    v_cos_f32 v48, v91
    v_sin_f32_e64 v49, v91
    v_mov_b32 v144, 0x3f80
    v_lshlrev_b32 v245, 16, v245
    v_cndmask_b32 v131, 0, v245, vcc
    v_pk_mul_f32 v[50:51], v[50:51], v[240:241] op_sel_hi:[1,0]
    v_pk_mul_f32 v[48:49], v[48:49], v[90:91] op_sel_hi:[1,0]
    v_cvt_pk_bf16_f32 v145, v50, v51
    v_pk_mul_f32 v[90:91], v[50:51], v[50:51] op_sel_hi:[1,0]
    v_pk_fma_f32 v[52:53], v[50:51], v[50:51], v[90:91] op_sel:[1,1,0] op_sel_hi:[0,1,1] neg_lo:[1,0,0]
    v_cvt_pk_bf16_f32 v146, v52, v53
    v_pk_mul_f32 v[90:91], v[52:53], v[50:51] op_sel_hi:[1,0]
    buffer_load_dwordx4 v5, s[44:47], s3 offen offset:1024 lds
    v_pk_fma_f32 v[54:55], v[52:53], v[50:51], v[90:91] op_sel:[1,1,0] op_sel_hi:[0,1,1] neg_lo:[1,0,0]
    v_cvt_pk_bf16_f32 v147, v54, v55
    v_pk_mul_f32 v[90:91], v[54:55], v[50:51] op_sel_hi:[1,0]
    v_pk_fma_f32 v[56:57], v[54:55], v[50:51], v[90:91] op_sel:[1,1,0] op_sel_hi:[0,1,1] neg_lo:[1,0,0]
    v_cvt_pk_bf16_f32 v148, v56, v57
    v_pk_mul_f32 v[90:91], v[56:57], v[50:51] op_sel_hi:[1,0]
    v_pk_fma_f32 v[58:59], v[56:57], v[50:51], v[90:91] op_sel:[1,1,0] op_sel_hi:[0,1,1] neg_lo:[1,0,0]
    v_cvt_pk_bf16_f32 v149, v58, v59
    v_pk_mul_f32 v[90:91], v[58:59], v[50:51] op_sel_hi:[1,0]
    v_pk_fma_f32 v[60:61], v[58:59], v[50:51], v[90:91] op_sel:[1,1,0] op_sel_hi:[0,1,1] neg_lo:[1,0,0]
    v_cvt_pk_bf16_f32 v150, v60, v61
    v_pk_mul_f32 v[90:91], v[60:61], v[50:51] op_sel_hi:[1,0]
    v_pk_fma_f32 v[62:63], v[60:61], v[50:51], v[90:91] op_sel:[1,1,0] op_sel_hi:[0,1,1] neg_lo:[1,0,0]
    v_cvt_pk_bf16_f32 v151, v62, v63
    v_pk_mul_f32 v[90:91], v[62:63], v[50:51] op_sel_hi:[1,0]
    v_pk_fma_f32 v[64:65], v[62:63], v[50:51], v[90:91] op_sel:[1,1,0] op_sel_hi:[0,1,1] neg_lo:[1,0,0]
    v_cvt_pk_bf16_f32 v152, v64, v65
    v_pk_mul_f32 v[90:91], v[64:65], v[50:51] op_sel_hi:[1,0]
    v_pk_fma_f32 v[66:67], v[64:65], v[50:51], v[90:91] op_sel:[1,1,0] op_sel_hi:[0,1,1] neg_lo:[1,0,0]
    v_cvt_pk_bf16_f32 v153, v66, v67
    v_pk_mul_f32 v[90:91], v[66:67], v[50:51] op_sel_hi:[1,0]
    buffer_load_dwordx4 v6, s[44:47], s3 offen offset:2048 lds
    v_pk_fma_f32 v[68:69], v[66:67], v[50:51], v[90:91] op_sel:[1,1,0] op_sel_hi:[0,1,1] neg_lo:[1,0,0]
    v_cvt_pk_bf16_f32 v154, v68, v69
    v_pk_mul_f32 v[90:91], v[68:69], v[50:51] op_sel_hi:[1,0]
    v_pk_fma_f32 v[70:71], v[68:69], v[50:51], v[90:91] op_sel:[1,1,0] op_sel_hi:[0,1,1] neg_lo:[1,0,0]
    v_cvt_pk_bf16_f32 v155, v70, v71
    v_pk_mul_f32 v[90:91], v[70:71], v[50:51] op_sel_hi:[1,0]
    v_pk_fma_f32 v[72:73], v[70:71], v[50:51], v[90:91] op_sel:[1,1,0] op_sel_hi:[0,1,1] neg_lo:[1,0,0]
    v_cvt_pk_bf16_f32 v156, v72, v73
    v_pk_mul_f32 v[90:91], v[72:73], v[50:51] op_sel_hi:[1,0]
    v_pk_fma_f32 v[74:75], v[72:73], v[50:51], v[90:91] op_sel:[1,1,0] op_sel_hi:[0,1,1] neg_lo:[1,0,0]
    v_cvt_pk_bf16_f32 v157, v74, v75
    v_pk_mul_f32 v[90:91], v[74:75], v[50:51] op_sel_hi:[1,0]
    v_pk_fma_f32 v[76:77], v[74:75], v[50:51], v[90:91] op_sel:[1,1,0] op_sel_hi:[0,1,1] neg_lo:[1,0,0]
    v_cvt_pk_bf16_f32 v158, v76, v77
    v_pk_mul_f32 v[90:91], v[76:77], v[50:51] op_sel_hi:[1,0]
    v_pk_fma_f32 v[78:79], v[76:77], v[50:51], v[90:91] op_sel:[1,1,0] op_sel_hi:[0,1,1] neg_lo:[1,0,0]
    v_cvt_pk_bf16_f32 v159, v78, v79
    v_pk_mul_f32 v[90:91], v[78:79], v[50:51] op_sel_hi:[1,0]
    v_pk_fma_f32 v[80:81], v[78:79], v[50:51], v[90:91] op_sel:[1,1,0] op_sel_hi:[0,1,1] neg_lo:[1,0,0]
    v_cvt_pk_bf16_f32 v191, v82, v83
    ds_write2st64_b32 v112, v144, v191 offset0:0 offset1:188
    buffer_load_dwordx4 v7, s[44:47], s3 offen offset:3072 lds
    v_pk_mul_f32 v[90:91], v[82:83], v[80:81] op_sel_hi:[1,0]
    v_pk_fma_f32 v[84:85], v[82:83], v[80:81], v[90:91] op_sel:[1,1,0] op_sel_hi:[0,1,1] neg_hi:[1,0,0]
    v_cvt_pk_bf16_f32 v192, v84, v85
    ds_write2st64_b32 v113, v145, v192 offset0:4 offset1:192
    v_pk_mul_f32 v[90:91], v[84:85], v[80:81] op_sel_hi:[1,0]
    v_pk_fma_f32 v[82:83], v[84:85], v[80:81], v[90:91] op_sel:[1,1,0] op_sel_hi:[0,1,1] neg_hi:[1,0,0]
    v_cvt_pk_bf16_f32 v193, v82, v83
    ds_write2st64_b32 v114, v146, v193 offset0:8 offset1:196
    v_pk_mul_f32 v[90:91], v[82:83], v[80:81] op_sel_hi:[1,0]
    v_pk_fma_f32 v[84:85], v[82:83], v[80:81], v[90:91] op_sel:[1,1,0] op_sel_hi:[0,1,1] neg_hi:[1,0,0]
    v_cvt_pk_bf16_f32 v194, v84, v85
    ds_write2st64_b32 v115, v147, v194 offset0:12 offset1:200
    v_pk_mul_f32 v[90:91], v[84:85], v[80:81] op_sel_hi:[1,0]
    v_pk_fma_f32 v[82:83], v[84:85], v[80:81], v[90:91] op_sel:[1,1,0] op_sel_hi:[0,1,1] neg_hi:[1,0,0]
    v_cvt_pk_bf16_f32 v195, v82, v83
    ds_write2st64_b32 v116, v148, v195 offset0:16 offset1:204
    v_pk_mul_f32 v[90:91], v[82:83], v[80:81] op_sel_hi:[1,0]
    v_pk_fma_f32 v[84:85], v[82:83], v[80:81], v[90:91] op_sel:[1,1,0] op_sel_hi:[0,1,1] neg_hi:[1,0,0]
    v_cvt_pk_bf16_f32 v196, v84, v85
    ds_write2st64_b32 v117, v149, v196 offset0:20 offset1:208
    v_pk_mul_f32 v[90:91], v[84:85], v[80:81] op_sel_hi:[1,0]
    s_add_u32 m0, s73, 114688
    s_lshl4_add_u32 s3, s76, s72
    buffer_load_dwordx4 v4, s[44:47], s3 offen offset:0 lds
    v_pk_fma_f32 v[82:83], v[84:85], v[80:81], v[90:91] op_sel:[1,1,0] op_sel_hi:[0,1,1] neg_hi:[1,0,0]
    v_cvt_pk_bf16_f32 v197, v82, v83
    ds_write2st64_b32 v118, v150, v197 offset0:24 offset1:212
    v_pk_mul_f32 v[90:91], v[82:83], v[80:81] op_sel_hi:[1,0]
    v_pk_fma_f32 v[84:85], v[82:83], v[80:81], v[90:91] op_sel:[1,1,0] op_sel_hi:[0,1,1] neg_hi:[1,0,0]
    v_cvt_pk_bf16_f32 v198, v84, v85
    ds_write2st64_b32 v119, v151, v198 offset0:28 offset1:216
    v_pk_mul_f32 v[90:91], v[84:85], v[80:81] op_sel_hi:[1,0]
    v_pk_fma_f32 v[82:83], v[84:85], v[80:81], v[90:91] op_sel:[1,1,0] op_sel_hi:[0,1,1] neg_hi:[1,0,0]
    v_cvt_pk_bf16_f32 v199, v82, v83
    ds_write2st64_b32 v120, v152, v199 offset0:32 offset1:220
    v_pk_mul_f32 v[90:91], v[82:83], v[80:81] op_sel_hi:[1,0]
    v_pk_fma_f32 v[84:85], v[82:83], v[80:81], v[90:91] op_sel:[1,1,0] op_sel_hi:[0,1,1] neg_hi:[1,0,0]
    v_cvt_pk_bf16_f32 v200, v84, v85
    ds_write2st64_b32 v121, v153, v200 offset0:36 offset1:224
    v_pk_mul_f32 v[90:91], v[84:85], v[80:81] op_sel_hi:[1,0]
    v_pk_fma_f32 v[82:83], v[84:85], v[80:81], v[90:91] op_sel:[1,1,0] op_sel_hi:[0,1,1] neg_hi:[1,0,0]
    v_cvt_pk_bf16_f32 v201, v82, v83
    ds_write2st64_b32 v122, v154, v201 offset0:40 offset1:228
    v_pk_mul_f32 v[90:91], v[82:83], v[80:81] op_sel_hi:[1,0]
    v_pk_fma_f32 v[84:85], v[82:83], v[80:81], v[90:91] op_sel:[1,1,0] op_sel_hi:[0,1,1] neg_hi:[1,0,0]
    buffer_load_dwordx4 v5, s[44:47], s3 offen offset:1024 lds
    v_cvt_pk_bf16_f32 v202, v84, v85
    ds_write2st64_b32 v123, v155, v202 offset0:44 offset1:232
    v_pk_mul_f32 v[90:91], v[84:85], v[80:81] op_sel_hi:[1,0]
    v_pk_fma_f32 v[82:83], v[84:85], v[80:81], v[90:91] op_sel:[1,1,0] op_sel_hi:[0,1,1] neg_hi:[1,0,0]
    v_cvt_pk_bf16_f32 v203, v82, v83
    ds_write2st64_b32 v124, v156, v203 offset0:48 offset1:236
    v_pk_mul_f32 v[90:91], v[82:83], v[80:81] op_sel_hi:[1,0]
    v_pk_fma_f32 v[84:85], v[82:83], v[80:81], v[90:91] op_sel:[1,1,0] op_sel_hi:[0,1,1] neg_hi:[1,0,0]
    v_cvt_pk_bf16_f32 v204, v84, v85
    ds_write2st64_b32 v125, v157, v204 offset0:52 offset1:240
    v_pk_mul_f32 v[90:91], v[84:85], v[80:81] op_sel_hi:[1,0]
    v_pk_fma_f32 v[82:83], v[84:85], v[80:81], v[90:91] op_sel:[1,1,0] op_sel_hi:[0,1,1] neg_hi:[1,0,0]
    v_cvt_pk_bf16_f32 v205, v82, v83
    ds_write2st64_b32 v126, v158, v205 offset0:56 offset1:244
    v_pk_mul_f32 v[90:91], v[82:83], v[80:81] op_sel_hi:[1,0]
    v_pk_fma_f32 v[84:85], v[82:83], v[80:81], v[90:91] op_sel:[1,1,0] op_sel_hi:[0,1,1] neg_hi:[1,0,0]
    v_cvt_pk_bf16_f32 v206, v84, v85
    ds_write2st64_b32 v127, v159, v206 offset0:60 offset1:248
    v_cvt_pk_bf16_f32 v160, v48, v49
    v_pk_mul_f32 v[90:91], v[48:49], v[52:53] op_sel_hi:[1,0]
    v_pk_fma_f32 v[82:83], v[48:49], v[52:53], v[90:91] op_sel:[1,1,0] op_sel_hi:[0,1,1] neg_lo:[1,0,0]
    buffer_load_dwordx4 v6, s[44:47], s3 offen offset:2048 lds
    v_cvt_pk_bf16_f32 v161, v82, v83
    v_pk_mul_f32 v[90:91], v[48:49], v[56:57] op_sel_hi:[1,0]
    v_pk_fma_f32 v[82:83], v[48:49], v[56:57], v[90:91] op_sel:[1,1,0] op_sel_hi:[0,1,1] neg_lo:[1,0,0]
    v_cvt_pk_bf16_f32 v162, v82, v83
    v_pk_mul_f32 v[90:91], v[48:49], v[60:61] op_sel_hi:[1,0]
    v_pk_fma_f32 v[82:83], v[48:49], v[60:61], v[90:91] op_sel:[1,1,0] op_sel_hi:[0,1,1] neg_lo:[1,0,0]
    v_cvt_pk_bf16_f32 v163, v82, v83
    v_pk_mul_f32 v[90:91], v[48:49], v[64:65] op_sel_hi:[1,0]
    v_pk_fma_f32 v[82:83], v[48:49], v[64:65], v[90:91] op_sel:[1,1,0] op_sel_hi:[0,1,1] neg_lo:[1,0,0]
    v_cvt_pk_bf16_f32 v164, v82, v83
    v_pk_mul_f32 v[90:91], v[48:49], v[68:69] op_sel_hi:[1,0]
    v_pk_fma_f32 v[82:83], v[48:49], v[68:69], v[90:91] op_sel:[1,1,0] op_sel_hi:[0,1,1] neg_lo:[1,0,0]
    v_cvt_pk_bf16_f32 v165, v82, v83
    v_pk_mul_f32 v[90:91], v[48:49], v[72:73] op_sel_hi:[1,0]
    v_pk_fma_f32 v[82:83], v[48:49], v[72:73], v[90:91] op_sel:[1,1,0] op_sel_hi:[0,1,1] neg_lo:[1,0,0]
    v_cvt_pk_bf16_f32 v166, v82, v83
    v_pk_mul_f32 v[90:91], v[48:49], v[76:77] op_sel_hi:[1,0]
    v_pk_fma_f32 v[82:83], v[48:49], v[76:77], v[90:91] op_sel:[1,1,0] op_sel_hi:[0,1,1] neg_lo:[1,0,0]
    v_cvt_pk_bf16_f32 v167, v82, v83
    v_pk_mul_f32 v[90:91], v[48:49], v[80:81] op_sel_hi:[1,0]
    v_pk_fma_f32 v[82:83], v[48:49], v[80:81], v[90:91] op_sel:[1,1,0] op_sel_hi:[0,1,1] neg_lo:[1,0,0]
    buffer_load_dwordx4 v7, s[44:47], s3 offen offset:3072 lds
    v_cvt_pk_bf16_f32 v168, v82, v83
    ds_write2st64_b32 v112, v160, v168 offset0:64 offset1:96
    v_pk_mul_f32 v[90:91], v[48:49], v[48:49] op_sel_hi:[1,0]
    v_pk_fma_f32 v[86:87], v[48:49], v[48:49], v[90:91] op_sel:[1,1,0] op_sel_hi:[0,1,1] neg_lo:[1,0,0]
    v_cvt_pk_bf16_f32 v169, v86, v87
    ds_write2st64_b32 v114, v161, v169 offset0:68 offset1:100
    v_pk_mul_f32 v[90:91], v[86:87], v[56:57] op_sel_hi:[1,0]
    v_pk_fma_f32 v[82:83], v[86:87], v[56:57], v[90:91] op_sel:[1,1,0] op_sel_hi:[0,1,1] neg_lo:[1,0,0]
    v_cvt_pk_bf16_f32 v170, v82, v83
    ds_write2st64_b32 v116, v162, v170 offset0:72 offset1:104
    v_pk_mul_f32 v[90:91], v[86:87], v[64:65] op_sel_hi:[1,0]
    v_pk_fma_f32 v[82:83], v[86:87], v[64:65], v[90:91] op_sel:[1,1,0] op_sel_hi:[0,1,1] neg_lo:[1,0,0]
    v_cvt_pk_bf16_f32 v171, v82, v83
    ds_write2st64_b32 v118, v163, v171 offset0:76 offset1:108
    v_pk_mul_f32 v[90:91], v[86:87], v[72:73] op_sel_hi:[1,0]
    v_pk_fma_f32 v[82:83], v[86:87], v[72:73], v[90:91] op_sel:[1,1,0] op_sel_hi:[0,1,1] neg_lo:[1,0,0]
    v_cvt_pk_bf16_f32 v172, v82, v83
    ds_write2st64_b32 v120, v164, v172 offset0:80 offset1:112
    v_pk_mul_f32 v[90:91], v[86:87], v[80:81] op_sel_hi:[1,0]
    v_pk_fma_f32 v[82:83], v[86:87], v[80:81], v[90:91] op_sel:[1,1,0] op_sel_hi:[0,1,1] neg_lo:[1,0,0]
    v_cvt_pk_bf16_f32 v173, v82, v83
    s_add_u32 m0, s73, 0
    s_lshl4_add_u32 s3, s77, s72
    buffer_load_dwordx4 v4, s[44:47], s3 offen offset:0 lds
    ds_write2st64_b32 v122, v165, v173 offset0:84 offset1:116
    v_pk_mul_f32 v[90:91], v[86:87], v[48:49] op_sel_hi:[1,0]
    v_pk_fma_f32 v[88:89], v[86:87], v[48:49], v[90:91] op_sel:[1,1,0] op_sel_hi:[0,1,1] neg_lo:[1,0,0]
    v_cvt_pk_bf16_f32 v174, v88, v89
    ds_write2st64_b32 v124, v166, v174 offset0:88 offset1:120
    v_pk_mul_f32 v[90:91], v[88:89], v[56:57] op_sel_hi:[1,0]
    v_pk_fma_f32 v[82:83], v[88:89], v[56:57], v[90:91] op_sel:[1,1,0] op_sel_hi:[0,1,1] neg_lo:[1,0,0]
    v_cvt_pk_bf16_f32 v175, v82, v83
    ds_write2st64_b32 v126, v167, v175 offset0:92 offset1:124
    v_pk_mul_f32 v[90:91], v[88:89], v[64:65] op_sel_hi:[1,0]
    v_pk_fma_f32 v[82:83], v[88:89], v[64:65], v[90:91] op_sel:[1,1,0] op_sel_hi:[0,1,1] neg_lo:[1,0,0]
    v_cvt_pk_bf16_f32 v176, v82, v83
    v_pk_mul_f32 v[90:91], v[88:89], v[72:73] op_sel_hi:[1,0]
    v_pk_fma_f32 v[82:83], v[88:89], v[72:73], v[90:91] op_sel:[1,1,0] op_sel_hi:[0,1,1] neg_lo:[1,0,0]
    v_cvt_pk_bf16_f32 v177, v82, v83
    v_pk_mul_f32 v[90:91], v[88:89], v[80:81] op_sel_hi:[1,0]
    v_pk_fma_f32 v[82:83], v[88:89], v[80:81], v[90:91] op_sel:[1,1,0] op_sel_hi:[0,1,1] neg_lo:[1,0,0]
    v_cvt_pk_bf16_f32 v178, v82, v83
    v_pk_mul_f32 v[90:91], v[88:89], v[48:49] op_sel_hi:[1,0]
    v_pk_fma_f32 v[86:87], v[88:89], v[48:49], v[90:91] op_sel:[1,1,0] op_sel_hi:[0,1,1] neg_lo:[1,0,0]
    v_cvt_pk_bf16_f32 v179, v86, v87
    buffer_load_dwordx4 v5, s[44:47], s3 offen offset:1024 lds
    v_pk_mul_f32 v[90:91], v[86:87], v[64:65] op_sel_hi:[1,0]
    v_pk_fma_f32 v[82:83], v[86:87], v[64:65], v[90:91] op_sel:[1,1,0] op_sel_hi:[0,1,1] neg_lo:[1,0,0]
    v_cvt_pk_bf16_f32 v180, v82, v83
    v_pk_mul_f32 v[90:91], v[86:87], v[80:81] op_sel_hi:[1,0]
    v_pk_fma_f32 v[82:83], v[86:87], v[80:81], v[90:91] op_sel:[1,1,0] op_sel_hi:[0,1,1] neg_lo:[1,0,0]
    v_cvt_pk_bf16_f32 v181, v82, v83
    v_pk_mul_f32 v[90:91], v[86:87], v[48:49] op_sel_hi:[1,0]
    v_pk_fma_f32 v[88:89], v[86:87], v[48:49], v[90:91] op_sel:[1,1,0] op_sel_hi:[0,1,1] neg_lo:[1,0,0]
    v_cvt_pk_bf16_f32 v182, v88, v89
    v_pk_mul_f32 v[90:91], v[88:89], v[64:65] op_sel_hi:[1,0]
    v_pk_fma_f32 v[82:83], v[88:89], v[64:65], v[90:91] op_sel:[1,1,0] op_sel_hi:[0,1,1] neg_lo:[1,0,0]
    v_cvt_pk_bf16_f32 v183, v82, v83
    ds_write_b32 v126, v183 offset:39936
    v_pk_mul_f32 v[90:91], v[88:89], v[80:81] op_sel_hi:[1,0]
    v_pk_fma_f32 v[82:83], v[88:89], v[80:81], v[90:91] op_sel:[1,1,0] op_sel_hi:[0,1,1] neg_lo:[1,0,0]
    v_cvt_pk_bf16_f32 v184, v82, v83
    ds_write2st64_b32 v112, v176, v184 offset0:128 offset1:160
    v_pk_mul_f32 v[90:91], v[88:89], v[48:49] op_sel_hi:[1,0]
    v_pk_fma_f32 v[86:87], v[88:89], v[48:49], v[90:91] op_sel:[1,1,0] op_sel_hi:[0,1,1] neg_lo:[1,0,0]
    v_cvt_pk_bf16_f32 v185, v86, v87
    ds_write2st64_b32 v114, v177, v185 offset0:132 offset1:164
    buffer_load_dwordx4 v6, s[44:47], s3 offen offset:2048 lds
    v_pk_mul_f32 v[90:91], v[86:87], v[64:65] op_sel_hi:[1,0]
    v_pk_fma_f32 v[82:83], v[86:87], v[64:65], v[90:91] op_sel:[1,1,0] op_sel_hi:[0,1,1] neg_lo:[1,0,0]
    v_cvt_pk_bf16_f32 v186, v82, v83
    ds_write2st64_b32 v116, v178, v186 offset0:136 offset1:168
    v_pk_mul_f32 v[90:91], v[86:87], v[80:81] op_sel_hi:[1,0]
    v_pk_fma_f32 v[82:83], v[86:87], v[80:81], v[90:91] op_sel:[1,1,0] op_sel_hi:[0,1,1] neg_lo:[1,0,0]
    v_cvt_pk_bf16_f32 v187, v82, v83
    ds_write2st64_b32 v118, v179, v187 offset0:140 offset1:172
    v_pk_mul_f32 v[90:91], v[86:87], v[48:49] op_sel_hi:[1,0]
    v_pk_fma_f32 v[88:89], v[86:87], v[48:49], v[90:91] op_sel:[1,1,0] op_sel_hi:[0,1,1] neg_lo:[1,0,0]
    v_cvt_pk_bf16_f32 v188, v88, v89
    ds_write2st64_b32 v120, v180, v188 offset0:144 offset1:176
    v_pk_mul_f32 v[90:91], v[88:89], v[64:65] op_sel_hi:[1,0]
    v_pk_fma_f32 v[82:83], v[88:89], v[64:65], v[90:91] op_sel:[1,1,0] op_sel_hi:[0,1,1] neg_lo:[1,0,0]
    v_cvt_pk_bf16_f32 v189, v82, v83
    ds_write2st64_b32 v122, v181, v189 offset0:148 offset1:180
    v_pk_mul_f32 v[90:91], v[88:89], v[80:81] op_sel_hi:[1,0]
    v_pk_fma_f32 v[82:83], v[88:89], v[80:81], v[90:91] op_sel:[1,1,0] op_sel_hi:[0,1,1] neg_lo:[1,0,0]
    v_cvt_pk_bf16_f32 v190, v82, v83
    ds_write2st64_b32 v124, v182, v190 offset0:152 offset1:184
    buffer_load_dwordx4 v7, s[44:47], s3 offen offset:3072 lds
    s_waitcnt lgkmcnt(0)
    s_barrier
    ds_read_b128 v[144:147], v208 offset:48128
    ds_read_b128 v[148:151], v212 offset:0
    ds_read_b128 v[152:155], v216 offset:0
    ds_read_b128 v[156:159], v220 offset:0
    ds_read_b128 v[160:163], v224 offset:0
    ds_read_b128 v[164:167], v209 offset:48128
    ds_read_b128 v[168:171], v213 offset:0
    ds_read_b128 v[172:175], v217 offset:0
    ds_read_b128 v[176:179], v221 offset:0
    ds_read_b128 v[180:183], v225 offset:0
    s_waitcnt lgkmcnt(5)
    v_mfma_f32_16x16x32_bf16 v[128:131], v[148:151], v[144:147], v[128:131]
    ds_read_b128 v[184:187], v210 offset:48128
    v_mfma_f32_16x16x32_bf16 v[132:135], v[152:155], v[144:147], 0
    ds_read_b128 v[188:191], v214 offset:0
    v_mfma_f32_16x16x32_bf16 v[136:139], v[156:159], v[144:147], 0
    ds_read_b128 v[192:195], v218 offset:0
    v_mfma_f32_16x16x32_bf16 v[140:143], v[160:163], v[144:147], 0
    ds_read_b128 v[196:199], v222 offset:0
    ds_read_b128 v[200:203], v226 offset:0
    s_waitcnt lgkmcnt(5)
    v_mfma_f32_16x16x32_bf16 v[128:131], v[168:171], v[164:167], v[128:131]
    ds_read_b128 v[144:147], v211 offset:48128
    v_mfma_f32_16x16x32_bf16 v[132:135], v[172:175], v[164:167], v[132:135]
    ds_read_b128 v[148:151], v215 offset:0
    v_mfma_f32_16x16x32_bf16 v[136:139], v[176:179], v[164:167], v[136:139]
    ds_read_b128 v[152:155], v219 offset:0
    v_mfma_f32_16x16x32_bf16 v[140:143], v[180:183], v[164:167], v[140:143]
    ds_read_b128 v[156:159], v223 offset:0
    ds_read_b128 v[160:163], v227 offset:0
    s_waitcnt lgkmcnt(5)
    v_mfma_f32_16x16x32_bf16 v[128:131], v[188:191], v[184:187], v[128:131]
    ds_read_b128 v[164:167], v208 offset:48384
    v_mfma_f32_16x16x32_bf16 v[132:135], v[192:195], v[184:187], v[132:135]
    ds_read_b128 v[168:171], v212 offset:256
    v_mfma_f32_16x16x32_bf16 v[136:139], v[196:199], v[184:187], v[136:139]
    ds_read_b128 v[172:175], v216 offset:256
    v_mfma_f32_16x16x32_bf16 v[140:143], v[200:203], v[184:187], v[140:143]
    ds_read_b128 v[176:179], v220 offset:256
    ds_read_b128 v[180:183], v224 offset:256
    s_waitcnt lgkmcnt(5)
    v_mfma_f32_16x16x32_bf16 v[128:131], v[148:151], v[144:147], v[128:131]
    ds_read_b128 v[184:187], v209 offset:48384
    v_mfma_f32_16x16x32_bf16 v[132:135], v[152:155], v[144:147], v[132:135]
    ds_read_b128 v[188:191], v213 offset:256
    v_mfma_f32_16x16x32_bf16 v[136:139], v[156:159], v[144:147], v[136:139]
    ds_read_b128 v[192:195], v217 offset:256
    v_mfma_f32_16x16x32_bf16 v[140:143], v[160:163], v[144:147], v[140:143]
    ds_read_b128 v[196:199], v221 offset:256
    ds_read_b128 v[200:203], v225 offset:256
    buffer_load_dwordx2 v[36:37], v34, s[48:51], 0 offen sc1
    buffer_load_dword v13, v14, s[48:51], 0 offen sc1
    s_waitcnt lgkmcnt(5)
    v_mfma_f32_16x16x32_bf16 v[128:131], v[168:171], v[164:167], v[128:131]
    ds_read_b128 v[144:147], v210 offset:48384
    v_mfma_f32_16x16x32_bf16 v[132:135], v[172:175], v[164:167], v[132:135]
    ds_read_b128 v[148:151], v214 offset:256
    v_mfma_f32_16x16x32_bf16 v[136:139], v[176:179], v[164:167], v[136:139]
    ds_read_b128 v[152:155], v218 offset:256
    v_mfma_f32_16x16x32_bf16 v[140:143], v[180:183], v[164:167], v[140:143]
    ds_read_b128 v[156:159], v222 offset:256
    ds_read_b128 v[160:163], v226 offset:256
    s_waitcnt lgkmcnt(5)
    v_mfma_f32_16x16x32_bf16 v[128:131], v[188:191], v[184:187], v[128:131]
    ds_read_b128 v[164:167], v211 offset:48384
    v_mfma_f32_16x16x32_bf16 v[132:135], v[192:195], v[184:187], v[132:135]
    ds_read_b128 v[168:171], v215 offset:256
    v_mfma_f32_16x16x32_bf16 v[136:139], v[196:199], v[184:187], v[136:139]
    ds_read_b128 v[172:175], v219 offset:256
    v_mfma_f32_16x16x32_bf16 v[140:143], v[200:203], v[184:187], v[140:143]
    ds_read_b128 v[176:179], v223 offset:256
    ds_read_b128 v[180:183], v227 offset:256
    s_waitcnt lgkmcnt(5)
    v_mfma_f32_16x16x32_bf16 v[128:131], v[148:151], v[144:147], v[128:131]
    v_mfma_f32_16x16x32_bf16 v[132:135], v[152:155], v[144:147], v[132:135]
    v_mfma_f32_16x16x32_bf16 v[136:139], v[156:159], v[144:147], v[136:139]
    v_mfma_f32_16x16x32_bf16 v[140:143], v[160:163], v[144:147], v[140:143]
    s_waitcnt lgkmcnt(0)
    s_barrier
    v_mfma_f32_16x16x32_bf16 v[128:131], v[168:171], v[164:167], v[128:131]
    v_mfma_f32_16x16x32_bf16 v[132:135], v[172:175], v[164:167], v[132:135]
    v_mfma_f32_16x16x32_bf16 v[136:139], v[176:179], v[164:167], v[136:139]
    v_mfma_f32_16x16x32_bf16 v[140:143], v[180:183], v[164:167], v[140:143]
    s_add_u32 m0, s73, 98304
    s_lshl4_add_u32 s3, s74, s72
    buffer_load_dwordx4 v4, s[44:47], s3 offen offset:0 lds
    s_mul_i32 s84, s56, 4224
    s_add_u32 s84, s84, 49280
    s_mul_i32 s61, s56, 4640
    s_add_u32 s61, s61, 70400
    v_lshl_add_u32 v205, v0, 2, s61
    s_sub_u32 s61, s84, 128
    v_and_b32 v206, 31, v0
    v_lshl_add_u32 v206, v206, 2, s61
    s_mul_i32 s61, s87, 9280
    s_lshl_b32 s63, s95, 11
    buffer_load_dwordx4 v5, s[44:47], s3 offen offset:1024 lds
    s_sub_u32 s61, s61, s63
    s_add_u32 s61, s61, 70368
    v_lshlrev_b32 v204, 5, v0
    v_sub_u32 v204, s61, v204
    v_cvt_pk_bf16_f32 v144, v128, v129
    v_cvt_pk_bf16_f32 v145, v130, v131
    v_cvt_pk_bf16_f32 v146, v132, v133
    v_cvt_pk_bf16_f32 v147, v134, v135
    v_cvt_pk_bf16_f32 v148, v136, v137
    v_cvt_pk_bf16_f32 v149, v138, v139
    buffer_load_dwordx4 v6, s[44:47], s3 offen offset:2048 lds
    v_cvt_pk_bf16_f32 v150, v140, v141
    v_cvt_pk_bf16_f32 v151, v142, v143
    v_permlane32_swap_b32 v144, v148
    v_permlane32_swap_b32 v146, v150
    v_permlane32_swap_b32 v145, v149
    v_permlane32_swap_b32 v147, v151
    v_permlane16_swap_b32 v144, v146
    v_permlane16_swap_b32 v148, v150
    v_permlane16_swap_b32 v145, v147
    v_permlane16_swap_b32 v149, v151
    buffer_load_dwordx4 v7, s[44:47], s3 offen offset:3072 lds
    s_lshl_b32 s94, s95, 4
    v_bfe_u32 v152, v151, 16, s94
    v_alignbit_b32 v154, v145, v144, 16
    v_alignbit_b32 v155, v146, v145, 16
    v_alignbit_b32 v156, v147, v146, 16
    v_alignbit_b32 v157, v148, v147, 16
    v_alignbit_b32 v158, v149, v148, 16
    v_alignbit_b32 v159, v150, v149, 16
    v_alignbit_b32 v160, v151, v150, 16
    v_mov_b32_dpp v152, v144 wave_shr:1 row_mask:0xf bank_mask:0xf
    v_alignbit_b32 v161, v152, v151, 16
    s_waitcnt vmcnt(4)
    v_cmp_ne_u32 vcc, v13, v2
    s_nop 0
    s_and_b64 vcc, vcc, s[14:15]
    s_cbranch_vccnz SLOW_SFU
BACK_SFU:
    s_barrier
    s_lshl1_add_u32 s61, s2, s87
    s_lshl_b32 s61, s61, 12
    s_lshl2_add_u32 s61, s95, s61
    s_add_u32 s3, s61, 8388604
    s_mov_b32 m0, s84
    s_nop 0
    buffer_load_dwordx4 v1, s[48:51], s3 offen offset:0 sc1 lds
    v_lshrrev_b32_e64 v19, 4, v0
    v_bfe_u32 v20, v0, 1, 3
    v_and_b32 v18, 1, v0
    s_lshl_b32 s61, s95, 8
    s_mul_i32 s62, s87, 9280
    buffer_load_dwordx4 v1, s[48:51], s3 offen offset:1024 sc1 lds
    s_add_u32 s62, s62, s61
    s_add_u32 s62, s62, 71392
    v_lshl_add_u32 v17, v19, 4, s62
    v_mul_u32_u24 v21, 4640, v18
    v_lshl_add_u32 v21, v20, 6, v21
    buffer_load_dwordx4 v1, s[48:51], s3 offen offset:2048 sc1 lds
    v_sub_u32 v17, v17, v21
    s_mul_i32 s62, s87, 8448
    s_add_u32 s62, s62, s61
    s_add_u32 s62, s62, 49224
    v_mul_u32_u24 v21, 4224, v18
    buffer_load_dwordx4 v1, s[48:51], s3 offen offset:3072 sc1 lds
    v_lshl_add_u32 v21, v19, 4, v21
    v_lshl_add_u32 v21, v20, 3, v21
    v_add_u32 v16, s62, v21
    s_lshl_b32 s61, s95, 2
    s_sub_u32 s61, s84, s61
    v_mov_b32_e64 v18, s61
    ds_write_b128 v204, v[144:147] offset:0
    ds_write_b128 v204, v[148:151] offset:16
    ds_write_b128 v204, v[154:157] offset:4640
    ds_write_b128 v204, v[158:161] offset:4656
    ds_write2st64_b32 v205, v12, v12 offset1:1
    ds_write_b32 v206, v12
    ds_write_b32 v33, v32
    v_cmp_ne_u32 vcc, v37, v2
    s_cbranch_vccnz SLOW_SG
BACK_SG:
    v_and_b32 v29, 0xffff0000, v36
    v_lshrrev_b32 v28, 16, v36
    v_sub_f32 v30, 1.0, v29
    v_cvt_pk_bf16_f32 v31, v30, 0
    v_lshlrev_b32 v30, 16, v31
    s_waitcnt vmcnt(4)
    s_barrier
    ds_read_b64_tr_b16 a[0:1], v10 offset:0
    ds_read_b64_tr_b16 a[2:3], v10 offset:1024
    ds_read_b64_tr_b16 a[4:5], v11 offset:0
    ds_read_b64_tr_b16 a[6:7], v11 offset:1024
    ds_read_b64_tr_b16 a[8:9], v10 offset:2048
    ds_read_b64_tr_b16 a[10:11], v10 offset:3072
    ds_read_b64_tr_b16 a[12:13], v11 offset:2048
    ds_read_b64_tr_b16 a[14:15], v11 offset:3072
    ds_read_b64_tr_b16 a[16:17], v10 offset:8192
    ds_read_b64_tr_b16 a[18:19], v10 offset:9216
    ds_read_b64_tr_b16 a[20:21], v11 offset:8192
    ds_read_b64_tr_b16 a[22:23], v11 offset:9216
    ds_read_b64_tr_b16 a[24:25], v10 offset:10240
    ds_read_b64_tr_b16 a[26:27], v10 offset:11264
    ds_read_b64_tr_b16 a[28:29], v11 offset:10240
    ds_read_b64_tr_b16 a[30:31], v11 offset:11264
    s_waitcnt vmcnt(0)
    s_nop 7
    s_branch L_JOIN
SLOW_NON:
    s_mov_b32 s94, 0x20000
LOOP_NON:
    s_sub_u32 s94, s94, 1
    s_cbranch_scc1 BACK_NON
    global_load_dword v2, v12, s[32:33] sc1
    s_waitcnt vmcnt(0) lgkmcnt(0)
    v_cmp_eq_u32 vcc, 0, v2
    s_cbranch_vccz BACK_NON
    s_branch LOOP_NON
SLOW_REC:
    s_mov_b32 s94, 0x20000
LOOP_REC:
    s_sub_u32 s94, s94, 1
    s_cbranch_scc1 BACK_REC
    buffer_load_dwordx4 v[128:131], v30, s[48:51], 0 offen offset:0 sc1
    buffer_load_dwordx4 v[132:135], v30, s[48:51], 0 offen offset:512 sc1
    buffer_load_dwordx4 v[136:139], v31, s[48:51], s90 offen sc1
    buffer_load_dwordx4 v[140:143], v31, s[48:51], s92 offen sc1
    s_waitcnt vmcnt(0) lgkmcnt(0)
    v_bitop3_b32 v144, v131, v135, v2 bitop3:0x7e
    v_bitop3_b32 v145, v139, v143, v2 bitop3:0x7e
    v_bitop3_b32 v144, v145, v144, v3 bitop3:0xf4
    v_cmp_ne_u32 vcc, 0, v144
    s_cbranch_vccz BACK_REC
    s_branch LOOP_REC
SLOW_FU:
    s_mov_b32 s94, 0x20000
LOOP_FU:
    s_sub_u32 s94, s94, 1
    s_cbranch_scc1 BACK_FU
    buffer_load_dword v13, v14, s[48:51], 0 offen sc1
    s_waitcnt vmcnt(0) lgkmcnt(0)
    v_cmp_ne_u32 vcc, v13, v2
    s_nop 0
    s_and_b64 vcc, vcc, s[14:15]
    s_cbranch_vccz BACK_FU
    s_branch LOOP_FU
SLOW_SNON:
    s_mov_b32 s94, 0x20000
LOOP_SNON:
    s_sub_u32 s94, s94, 1
    s_cbranch_scc1 BACK_SNON
    global_load_dword v2, v12, s[32:33] sc1
    s_waitcnt vmcnt(0) lgkmcnt(0)
    v_cmp_eq_u32 vcc, 0, v2
    s_cbranch_vccz BACK_SNON
    s_branch LOOP_SNON
SLOW_SFU:
    s_mov_b32 s94, 0x20000
LOOP_SFU:
    s_sub_u32 s94, s94, 1
    s_cbranch_scc1 BACK_SFU
    buffer_load_dword v13, v14, s[48:51], 0 offen sc1
    s_waitcnt vmcnt(0) lgkmcnt(0)
    v_cmp_ne_u32 vcc, v13, v2
    s_nop 0
    s_and_b64 vcc, vcc, s[14:15]
    s_cbranch_vccz BACK_SFU
    s_branch LOOP_SFU
SLOW_SG:
    s_mov_b32 s94, 0x20000
LOOP_SG:
    s_sub_u32 s94, s94, 1
    s_cbranch_scc1 BACK_SG
    buffer_load_dwordx2 v[36:37], v34, s[48:51], 0 offen sc1
    s_waitcnt vmcnt(0) lgkmcnt(0)
    v_cmp_ne_u32 vcc, v37, v2
    s_cbranch_vccz BACK_SG
    s_branch LOOP_SG
SLOW_FH0:
    s_mov_b32 s94, 0x20000
LOOP_FH0:
    s_sub_u32 s94, s94, 1
    s_cbranch_scc1 BACK_FH0
    buffer_load_dword v19, v18, s[48:51], 0 offen offset:0 sc1
    s_waitcnt vmcnt(0) lgkmcnt(0)
    v_cmp_ne_u32 vcc, v19, v2
    s_nop 0
    s_and_b64 vcc, vcc, 0xff7f
    s_cbranch_vccz BACK_FH0
    s_branch LOOP_FH0
SVC_OL0:
    s_add_u32 s3, s85, s74
    buffer_load_dwordx4 v[224:227], v1, s[48:51], s3 offen offset:0 sc1
    buffer_load_dwordx4 v[228:231], v1, s[48:51], s3 offen offset:1024 sc1
    buffer_load_dwordx4 v[232:235], v1, s[48:51], s3 offen offset:2048 sc1
    buffer_load_dwordx4 v[236:239], v1, s[48:51], s3 offen offset:3072 sc1
    s_branch SVB_OL0
SVC_OW0:
    s_waitcnt vmcnt(21)
    s_branch SVB_OW0
SVC_OW1:
    s_waitcnt vmcnt(24)
    s_branch SVB_OW1
SLOW_FH1:
    s_mov_b32 s94, 0x20000
LOOP_FH1:
    s_sub_u32 s94, s94, 1
    s_cbranch_scc1 BACK_FH1
    buffer_load_dword v19, v18, s[48:51], 0 offen offset:128 sc1
    s_waitcnt vmcnt(0) lgkmcnt(0)
    v_cmp_ne_u32 vcc, v19, v2
    s_nop 0
    s_and_b64 vcc, vcc, 0x7f
    s_cbranch_vccz BACK_FH1
    s_branch LOOP_FH1
SVC_OL1:
    s_add_u32 s3, s86, s74
    buffer_load_dwordx4 v[240:243], v1, s[48:51], s3 offen offset:0 sc1
    buffer_load_dwordx4 v[244:247], v1, s[48:51], s3 offen offset:1024 sc1
    buffer_load_dwordx4 v[248:251], v1, s[48:51], s3 offen offset:2048 sc1
    buffer_load_dwordx4 v[252:255], v1, s[48:51], s3 offen offset:3072 sc1
    s_branch SVB_OL1
SLOW_A:
    s_mov_b32 s94, 0x20000
LOOP_A:
    s_sub_u32 s94, s94, 1
    s_cbranch_scc1 BACK_A
    s_mov_b32 m0, s91
    s_nop 0
    buffer_load_dwordx4 v27, s[48:51], s92 offen sc1 lds
    buffer_load_dwordx4 v27, s[48:51], s90 offen offset:1024 sc1 lds
    s_waitcnt vmcnt(0)
    ds_read2_b32 v[128:129], v22 offset0:0 offset1:32
    ds_read2_b32 v[130:131], v22 offset0:128 offset1:160
    ds_read2_b32 v[132:133], v25 offset0:0 offset1:32
    ds_read2_b32 v[134:135], v25 offset0:128 offset1:160
    s_waitcnt vmcnt(0) lgkmcnt(0)
    v_max3_u32 v26, v128, v129, v130
    v_max3_u32 v19, v131, v132, v133
    v_max3_u32 v26, v26, v134, v135
    v_max_u32 v26, v26, v19
    v_cmp_eq_u32 vcc, -1, v26
    s_cbranch_vccz BACK_A
    s_branch LOOP_A
SLOW_PX:
    s_mov_b32 s94, 0x20000
LOOP_PX:
    s_sub_u32 s94, s94, 1
    s_cbranch_scc1 BACK_PX
    buffer_load_dwordx4 v[180:183], v1, s[48:51], s19 offen offset:0 sc1
    buffer_load_dwordx4 v[184:187], v1, s[48:51], s19 offen offset:1024 sc1
    buffer_load_dwordx4 v[188:191], v1, s[48:51], s19 offen offset:2048 sc1
    s_waitcnt vmcnt(0) lgkmcnt(0)
    v_bitop3_b32 v26, v183, v187, v2 bitop3:0x7e
    v_bitop3_b32 v26, v26, v191, v2 bitop3:0xf6
    v_cmp_ne_u32 vcc, 0, v26
    s_cbranch_vccz BACK_PX
    s_branch LOOP_PX
    s_endpgm
.fill (gated_mix__ssm_conv_s4d__mixer_channel_mlp__prompt_kernel + 33280 - .) / 4, 4, 0xbf810000
.section .rodata,"a"
.p2align 6
.amdhsa_kernel gated_mix__ssm_conv_s4d__mixer_channel_mlp__prompt_kernel
  .amdhsa_next_free_vgpr 512
  .amdhsa_next_free_sgpr 102
  .amdhsa_accum_offset 256
  .amdhsa_group_segment_fixed_size 0
  .amdhsa_kernarg_size 128
  .amdhsa_user_sgpr_count 2
  .amdhsa_user_sgpr_kernarg_segment_ptr 1
  .amdhsa_system_sgpr_workgroup_id_x 1
.end_amdhsa_kernel
```
